```python
import torch

def _softmax(x, axis=-1):
    return torch.softmax(x, dim=axis)
def _gelu(x):
    return torch.nn.functional.gelu(x, approximate="tanh")
def _silu(x):
    return torch.nn.functional.silu(x)
def _sigmoid(x):
    return torch.sigmoid(x)
def _layernorm(x, axis=-1, eps=1e-5):
    m = x.mean(dim=axis, keepdim=True)
    v = x.var(dim=axis, keepdim=True, unbiased=False)
    return (x - m) / torch.sqrt(v + eps)
def _scatter_add(tgt, idx, src, axis=0):
    return tgt.clone().index_add_(axis, idx, src)
def _segment_sum(src, seg, n):
    out = torch.zeros((n,) + src.shape[1:], dtype=src.dtype)
    return out.index_add_(0, seg, src)
def _pad(x, pw):
    flat = tuple(v for pair in reversed(pw) for v in pair)
    return torch.nn.functional.pad(x, flat)

kernel_name = 'recurrent_scan__spectral_gfnet__glu_gated_bilinear__prompt'

def setup_inputs():

    _w = (lambda a: (lambda t: t.to(torch.bfloat16) if t.is_floating_point() else t)(torch.as_tensor(a)))
    def _A_setup():
        B, S, D = 1, 2048, 1024
        Df = D // 2 + 1
        return {
            "x": _w((lambda *s: torch.randn(*s, dtype=torch.bfloat16) * 0.2)(B, S, D)),
            "w_r": _w((lambda *s: torch.randn(*s, dtype=torch.bfloat16) * 1.6)(S, Df) * 0.02),
            "w_i": _w((lambda *s: torch.randn(*s, dtype=torch.bfloat16) * 1.6)(S, Df) * 0.02),
        }
    _A_in = _A_setup()

    def _B_setup():
        B, S, D, F = 1, 2048, 1024, 3584
        return {
            "x": _w((lambda *s: torch.randn(*s, dtype=torch.bfloat16) * 0.2)(B, S, D)),
            "w_gate": _w((lambda *s: torch.randn(*s, dtype=torch.bfloat16) * 0.8)(D, F) * (D ** -0.5)),
            "w_up": _w((lambda *s: torch.randn(*s, dtype=torch.bfloat16) * 0.8)(D, F) * (D ** -0.5)),
            "w_down": _w((lambda *s: torch.randn(*s, dtype=torch.bfloat16) * 0.8)(F, D) * (F ** -0.5)),
        }
    _B_in = _B_setup()

    return {
        "A_x": _A_in["x"],
        "A_w_r": _A_in["w_r"],
        "A_w_i": _A_in["w_i"],
        "B_x": _B_in["x"],
        "B_w_gate": _B_in["w_gate"],
        "B_w_up": _B_in["w_up"],
        "B_w_down": _B_in["w_down"],
    }

def reference(A_x, A_w_r, A_w_i, B_x, B_w_gate, B_w_up, B_w_down):
    def _A_ref(x, w_r, w_i):
        B, S, D = x.shape
        X = (lambda x, axes=(-2,-1): torch.fft.rfft2(x.float(), dim=axes))(x, axes=(-2, -1))
        W = w_r + 1j * w_i
        X = X * W
        y = (lambda x, s, axes=(-2,-1): torch.fft.irfft2(x, s=s, dim=axes).to(torch.bfloat16))(X, (S, D), axes=(-2, -1))
        return y

    def _B_ref(x, w_gate, w_up, w_down):
        g = torch.einsum("bsd,df->bsf", x, w_gate)
        u = torch.einsum("bsd,df->bsf", x, w_up)
        h = g * u
        return torch.einsum("bsf,fd->bsd", h, w_down)

    x = A_x
    xn = _layernorm(x, axis=-1)
    s = _A_ref(xn, A_w_r, A_w_i)
    g = _silu(_B_ref(xn, B_w_gate, B_w_up, B_w_down))
    return x + s * g
```

```asm
; @launch grid=(256,1,1) block=(512,1,1) lds=163840
.amdgcn_target "amdgcn-amd-amdhsa--gfx950"
.text
.globl recurrent_scan__spectral_gfnet__glu_gated_bilinear__prompt_kernel
.p2align 8
.type recurrent_scan__spectral_gfnet__glu_gated_bilinear__prompt_kernel,@function
recurrent_scan__spectral_gfnet__glu_gated_bilinear__prompt_kernel:

  s_cmp_ge_u32 s2, 256
  s_cbranch_scc1 k1_end
  v_lshrrev_b32 v1, 6, v0
  v_and_b32 v2, 63, v0
  v_readfirstlane_b32 s20, v1
  s_and_b32 s3, s2, 7
  s_lshr_b32 s4, s2, 3
  s_load_dwordx2 s[90:91], s[0:1], 72
  s_load_dwordx2 s[4:5], s[0:1], 0
  s_load_dwordx4 s[32:35], s[0:1], 8
  s_waitcnt lgkmcnt(0)
  s_add_u32 s92, s90, 0x3000000
  s_addc_u32 s93, s91, 0
  s_mov_b32 s94, 0x40000
  s_mov_b32 s95, 0x20000
  s_load_dword s88, s[92:93], 0
  s_cmp_ge_u32 s20, 4
  s_cbranch_scc1 p0_w
  s_lshr_b32 s21, s2, 6
  s_and_b32 s22, s2, 63
  s_lshr_b32 s23, s21, 1
  s_lshl_b32 s23, s23, 4
  s_and_b32 s21, s21, 1
  s_lshl_b32 s21, s21, 2
  s_add_u32 s23, s23, s21
  s_and_b32 s24, s20, 1
  s_lshl_b32 s24, s24, 1
  s_add_u32 s23, s23, s24
  s_lshr_b32 s24, s20, 1
  s_lshl_b32 s24, s24, 3
  s_add_u32 s23, s23, s24
  s_lshl_b32 s23, s23, 6
  s_add_u32 s23, s23, s22
  s_lshl_b32 s23, s23, 11
  s_add_u32 s24, s23, 0x20000
  v_lshlrev_b32 v3, 4, v2
  s_mov_b32 s8, s4
  s_mov_b32 s9, s5
  s_mov_b32 s10, 0x400000
  s_mov_b32 s11, 0x20000
  buffer_load_dwordx4 v[4:7], v3, s[8:11], s23 offen
  buffer_load_dwordx4 v[8:11], v3, s[8:11], s23 offen offset:1024
  buffer_load_dwordx4 v[12:15], v3, s[8:11], s24 offen
  buffer_load_dwordx4 v[16:19], v3, s[8:11], s24 offen offset:1024
  s_mov_b32 s12, s90
  s_mov_b32 s13, s91
  s_mov_b32 s14, 0x400000
  s_mov_b32 s15, 0x20000
  v_and_b32 v20, 31, v2
  v_lshrrev_b32 v21, 5, v2
  v_cvt_f32_u32 v22, v20
  v_cvt_f32_u32 v23, v21
  v_mul_f32 v23, 4.0, v23
  v_mul_f32 v24, 0xbd000000, v22
  v_mul_f32 v25, v23, v24
  v_fmamk_f32 v28, v24, 0x0, v25
  v_fmamk_f32 v29, v24, 0x3f800000, v25
  v_cos_f32 v30, v28
  v_cos_f32 v31, v29
  v_sin_f32 v28, v28
  v_sin_f32 v29, v29
  v_cvt_pk_bf16_f32 v52, v30, v31
  v_cvt_pk_bf16_f32 v60, v28, v29
  v_fmamk_f32 v28, v24, 0x40000000, v25
  v_fmamk_f32 v29, v24, 0x40400000, v25
  v_cos_f32 v30, v28
  v_cos_f32 v31, v29
  v_sin_f32 v28, v28
  v_sin_f32 v29, v29
  v_cvt_pk_bf16_f32 v53, v30, v31
  v_cvt_pk_bf16_f32 v61, v28, v29
  v_fmamk_f32 v28, v24, 0x41000000, v25
  v_fmamk_f32 v29, v24, 0x41100000, v25
  v_cos_f32 v30, v28
  v_cos_f32 v31, v29
  v_sin_f32 v28, v28
  v_sin_f32 v29, v29
  v_cvt_pk_bf16_f32 v54, v30, v31
  v_cvt_pk_bf16_f32 v62, v28, v29
  v_fmamk_f32 v28, v24, 0x41200000, v25
  v_fmamk_f32 v29, v24, 0x41300000, v25
  v_cos_f32 v30, v28
  v_cos_f32 v31, v29
  v_sin_f32 v28, v28
  v_sin_f32 v29, v29
  v_cvt_pk_bf16_f32 v55, v30, v31
  v_cvt_pk_bf16_f32 v63, v28, v29
  v_fmamk_f32 v28, v24, 0x41800000, v25
  v_fmamk_f32 v29, v24, 0x41880000, v25
  v_cos_f32 v30, v28
  v_cos_f32 v31, v29
  v_sin_f32 v28, v28
  v_sin_f32 v29, v29
  v_cvt_pk_bf16_f32 v56, v30, v31
  v_cvt_pk_bf16_f32 v64, v28, v29
  v_fmamk_f32 v28, v24, 0x41900000, v25
  v_fmamk_f32 v29, v24, 0x41980000, v25
  v_cos_f32 v30, v28
  v_cos_f32 v31, v29
  v_sin_f32 v28, v28
  v_sin_f32 v29, v29
  v_cvt_pk_bf16_f32 v57, v30, v31
  v_cvt_pk_bf16_f32 v65, v28, v29
  v_fmamk_f32 v28, v24, 0x41c00000, v25
  v_fmamk_f32 v29, v24, 0x41c80000, v25
  v_cos_f32 v30, v28
  v_cos_f32 v31, v29
  v_sin_f32 v28, v28
  v_sin_f32 v29, v29
  v_cvt_pk_bf16_f32 v58, v30, v31
  v_cvt_pk_bf16_f32 v66, v28, v29
  v_fmamk_f32 v28, v24, 0x41d00000, v25
  v_fmamk_f32 v29, v24, 0x41d80000, v25
  v_cos_f32 v30, v28
  v_cos_f32 v31, v29
  v_sin_f32 v28, v28
  v_sin_f32 v29, v29
  v_cvt_pk_bf16_f32 v59, v30, v31
  v_cvt_pk_bf16_f32 v67, v28, v29
  v_mul_f32 v24, 0xba800000, v22
  v_mul_f32 v25, v23, v24
  v_fmamk_f32 v28, v24, 0x0, v25
  v_fmamk_f32 v29, v24, 0x3f800000, v25
  v_cos_f32 v84, v28
  v_sin_f32 v100, v28
  v_cos_f32 v85, v29
  v_sin_f32 v101, v29
  v_fmamk_f32 v28, v24, 0x40000000, v25
  v_fmamk_f32 v29, v24, 0x40400000, v25
  v_cos_f32 v86, v28
  v_sin_f32 v102, v28
  v_cos_f32 v87, v29
  v_sin_f32 v103, v29
  v_fmamk_f32 v28, v24, 0x41000000, v25
  v_fmamk_f32 v29, v24, 0x41100000, v25
  v_cos_f32 v88, v28
  v_sin_f32 v104, v28
  v_cos_f32 v89, v29
  v_sin_f32 v105, v29
  v_fmamk_f32 v28, v24, 0x41200000, v25
  v_fmamk_f32 v29, v24, 0x41300000, v25
  v_cos_f32 v90, v28
  v_sin_f32 v106, v28
  v_cos_f32 v91, v29
  v_sin_f32 v107, v29
  v_fmamk_f32 v28, v24, 0x41800000, v25
  v_fmamk_f32 v29, v24, 0x41880000, v25
  v_cos_f32 v92, v28
  v_sin_f32 v108, v28
  v_cos_f32 v93, v29
  v_sin_f32 v109, v29
  v_fmamk_f32 v28, v24, 0x41900000, v25
  v_fmamk_f32 v29, v24, 0x41980000, v25
  v_cos_f32 v94, v28
  v_sin_f32 v110, v28
  v_cos_f32 v95, v29
  v_sin_f32 v111, v29
  v_fmamk_f32 v28, v24, 0x41c00000, v25
  v_fmamk_f32 v29, v24, 0x41c80000, v25
  v_cos_f32 v96, v28
  v_sin_f32 v112, v28
  v_cos_f32 v97, v29
  v_sin_f32 v113, v29
  v_fmamk_f32 v28, v24, 0x41d00000, v25
  v_fmamk_f32 v29, v24, 0x41d80000, v25
  v_cos_f32 v98, v28
  v_sin_f32 v114, v28
  v_cos_f32 v99, v29
  v_sin_f32 v115, v29
  v_and_b32 v26, 15, v2
  v_cvt_f32_u32 v26, v26
  v_mul_f32 v24, 0x3d000000, v26
  v_bfe_u32 v27, v2, 4, 1
  v_cvt_f32_u32 v27, v27
  v_mul_f32 v27, 0x3e800000, v27
  v_fma_f32 v25, v23, v24, v27
  v_fmamk_f32 v28, v24, 0x0, v25
  v_fmamk_f32 v29, v24, 0x3f800000, v25
  v_cos_f32 v30, v28
  v_cos_f32 v31, v29
  v_sin_f32 v28, v28
  v_sin_f32 v29, v29
  v_cvt_pk_bf16_f32 v68, v30, v31
  v_cvt_pk_bf16_f32 v76, v28, v29
  v_fmamk_f32 v28, v24, 0x40000000, v25
  v_fmamk_f32 v29, v24, 0x40400000, v25
  v_cos_f32 v30, v28
  v_cos_f32 v31, v29
  v_sin_f32 v28, v28
  v_sin_f32 v29, v29
  v_cvt_pk_bf16_f32 v69, v30, v31
  v_cvt_pk_bf16_f32 v77, v28, v29
  v_fmamk_f32 v28, v24, 0x41000000, v25
  v_fmamk_f32 v29, v24, 0x41100000, v25
  v_cos_f32 v30, v28
  v_cos_f32 v31, v29
  v_sin_f32 v28, v28
  v_sin_f32 v29, v29
  v_cvt_pk_bf16_f32 v70, v30, v31
  v_cvt_pk_bf16_f32 v78, v28, v29
  v_fmamk_f32 v28, v24, 0x41200000, v25
  v_fmamk_f32 v29, v24, 0x41300000, v25
  v_cos_f32 v30, v28
  v_cos_f32 v31, v29
  v_sin_f32 v28, v28
  v_sin_f32 v29, v29
  v_cvt_pk_bf16_f32 v71, v30, v31
  v_cvt_pk_bf16_f32 v79, v28, v29
  v_fmamk_f32 v28, v24, 0x41800000, v25
  v_fmamk_f32 v29, v24, 0x41880000, v25
  v_cos_f32 v30, v28
  v_cos_f32 v31, v29
  v_sin_f32 v28, v28
  v_sin_f32 v29, v29
  v_cvt_pk_bf16_f32 v72, v30, v31
  v_cvt_pk_bf16_f32 v80, v28, v29
  v_fmamk_f32 v28, v24, 0x41900000, v25
  v_fmamk_f32 v29, v24, 0x41980000, v25
  v_cos_f32 v30, v28
  v_cos_f32 v31, v29
  v_sin_f32 v28, v28
  v_sin_f32 v29, v29
  v_cvt_pk_bf16_f32 v73, v30, v31
  v_cvt_pk_bf16_f32 v81, v28, v29
  v_fmamk_f32 v28, v24, 0x41c00000, v25
  v_fmamk_f32 v29, v24, 0x41c80000, v25
  v_cos_f32 v30, v28
  v_cos_f32 v31, v29
  v_sin_f32 v28, v28
  v_sin_f32 v29, v29
  v_cvt_pk_bf16_f32 v74, v30, v31
  v_cvt_pk_bf16_f32 v82, v28, v29
  v_fmamk_f32 v28, v24, 0x41d00000, v25
  v_fmamk_f32 v29, v24, 0x41d80000, v25
  v_cos_f32 v30, v28
  v_cos_f32 v31, v29
  v_sin_f32 v28, v28
  v_sin_f32 v29, v29
  v_cvt_pk_bf16_f32 v75, v30, v31
  v_cvt_pk_bf16_f32 v83, v28, v29
  s_lshl_b32 s25, s20, 12
  s_add_u32 s25, s25, 0x20000
  v_add_u32 v180, s25, v3
  v_bfe_u32 v26, v2, 2, 2
  v_lshl_add_u32 v26, v21, 2, v26
  v_lshlrev_b32 v26, 6, v26
  v_bfe_u32 v27, v2, 4, 1
  v_lshl_add_u32 v26, v27, 5, v26
  v_and_b32 v27, 3, v2
  v_lshl_add_u32 v26, v27, 3, v26
  v_add_u32 v181, s25, v26
  v_lshlrev_b32 v26, 3, v20
  v_lshl_add_u32 v26, v21, 10, v26
  v_add_u32 v182, s25, v26
  s_waitcnt vmcnt(0)
  v_lshlrev_b32 v20, 16, v4
  v_and_b32 v21, 0xffff0000, v4
  v_lshlrev_b32 v22, 16, v5
  v_and_b32 v23, 0xffff0000, v5
  v_lshlrev_b32 v24, 16, v6
  v_and_b32 v25, 0xffff0000, v6
  v_lshlrev_b32 v26, 16, v7
  v_and_b32 v27, 0xffff0000, v7
  v_lshlrev_b32 v28, 16, v8
  v_and_b32 v29, 0xffff0000, v8
  v_lshlrev_b32 v30, 16, v9
  v_and_b32 v31, 0xffff0000, v9
  v_lshlrev_b32 v32, 16, v10
  v_and_b32 v33, 0xffff0000, v10
  v_lshlrev_b32 v34, 16, v11
  v_and_b32 v35, 0xffff0000, v11
  v_lshlrev_b32 v36, 16, v12
  v_and_b32 v37, 0xffff0000, v12
  v_lshlrev_b32 v38, 16, v13
  v_and_b32 v39, 0xffff0000, v13
  v_lshlrev_b32 v40, 16, v14
  v_and_b32 v41, 0xffff0000, v14
  v_lshlrev_b32 v42, 16, v15
  v_and_b32 v43, 0xffff0000, v15
  v_lshlrev_b32 v44, 16, v16
  v_and_b32 v45, 0xffff0000, v16
  v_lshlrev_b32 v46, 16, v17
  v_and_b32 v47, 0xffff0000, v17
  v_lshlrev_b32 v48, 16, v18
  v_and_b32 v49, 0xffff0000, v18
  v_lshlrev_b32 v50, 16, v19
  v_and_b32 v51, 0xffff0000, v19
  v_pk_add_f32 v[116:117], v[20:21], v[22:23]
  v_pk_add_f32 v[120:121], v[36:37], v[38:39]
  v_pk_add_f32 v[116:117], v[116:117], v[24:25]
  v_pk_add_f32 v[120:121], v[120:121], v[40:41]
  v_pk_add_f32 v[116:117], v[116:117], v[26:27]
  v_pk_add_f32 v[120:121], v[120:121], v[42:43]
  v_pk_add_f32 v[116:117], v[116:117], v[28:29]
  v_pk_add_f32 v[120:121], v[120:121], v[44:45]
  v_pk_add_f32 v[116:117], v[116:117], v[30:31]
  v_pk_add_f32 v[120:121], v[120:121], v[46:47]
  v_pk_add_f32 v[116:117], v[116:117], v[32:33]
  v_pk_add_f32 v[120:121], v[120:121], v[48:49]
  v_pk_add_f32 v[116:117], v[116:117], v[34:35]
  v_pk_add_f32 v[120:121], v[120:121], v[50:51]
  v_add_f32 v4, v116, v117
  v_add_f32 v5, v120, v121
  s_nop 0
  v_add_f32_dpp v4, v4, v4 quad_perm:[1,0,3,2] row_mask:0xf bank_mask:0xf
  v_add_f32_dpp v5, v5, v5 quad_perm:[1,0,3,2] row_mask:0xf bank_mask:0xf
  s_nop 0
  v_add_f32_dpp v4, v4, v4 quad_perm:[2,3,0,1] row_mask:0xf bank_mask:0xf
  v_add_f32_dpp v5, v5, v5 quad_perm:[2,3,0,1] row_mask:0xf bank_mask:0xf
  s_nop 0
  v_add_f32_dpp v4, v4, v4 row_half_mirror row_mask:0xf bank_mask:0xf
  v_add_f32_dpp v5, v5, v5 row_half_mirror row_mask:0xf bank_mask:0xf
  s_nop 0
  v_add_f32_dpp v4, v4, v4 row_mirror row_mask:0xf bank_mask:0xf
  v_add_f32_dpp v5, v5, v5 row_mirror row_mask:0xf bank_mask:0xf
  s_nop 0
  v_add_f32_dpp v4, v4, v4 row_bcast:15 row_mask:0xa bank_mask:0xf
  v_add_f32_dpp v5, v5, v5 row_bcast:15 row_mask:0xa bank_mask:0xf
  s_nop 0
  v_add_f32_dpp v4, v4, v4 row_bcast:31 row_mask:0xc bank_mask:0xf
  v_add_f32_dpp v5, v5, v5 row_bcast:31 row_mask:0xc bank_mask:0xf
  v_readlane_b32 s26, v4, 63
  v_readlane_b32 s27, v5, 63
  v_mov_b32 v6, 0xba800000
  v_mul_f32 v6, s26, v6
  v_mov_b32 v7, v6
  v_mov_b32 v8, 0xba800000
  v_mul_f32 v8, s27, v8
  v_mov_b32 v9, v8
  v_pk_add_f32 v[118:119], v[20:21], v[6:7]
  v_pk_add_f32 v[122:123], v[36:37], v[8:9]
  v_pk_mul_f32 v[116:117], v[118:119], v[118:119]
  v_pk_mul_f32 v[120:121], v[122:123], v[122:123]
  v_pk_add_f32 v[118:119], v[22:23], v[6:7]
  v_pk_add_f32 v[122:123], v[38:39], v[8:9]
  v_pk_fma_f32 v[116:117], v[118:119], v[118:119], v[116:117]
  v_pk_fma_f32 v[120:121], v[122:123], v[122:123], v[120:121]
  v_pk_add_f32 v[118:119], v[24:25], v[6:7]
  v_pk_add_f32 v[122:123], v[40:41], v[8:9]
  v_pk_fma_f32 v[116:117], v[118:119], v[118:119], v[116:117]
  v_pk_fma_f32 v[120:121], v[122:123], v[122:123], v[120:121]
  v_pk_add_f32 v[118:119], v[26:27], v[6:7]
  v_pk_add_f32 v[122:123], v[42:43], v[8:9]
  v_pk_fma_f32 v[116:117], v[118:119], v[118:119], v[116:117]
  v_pk_fma_f32 v[120:121], v[122:123], v[122:123], v[120:121]
  v_pk_add_f32 v[118:119], v[28:29], v[6:7]
  v_pk_add_f32 v[122:123], v[44:45], v[8:9]
  v_pk_fma_f32 v[116:117], v[118:119], v[118:119], v[116:117]
  v_pk_fma_f32 v[120:121], v[122:123], v[122:123], v[120:121]
  v_pk_add_f32 v[118:119], v[30:31], v[6:7]
  v_pk_add_f32 v[122:123], v[46:47], v[8:9]
  v_pk_fma_f32 v[116:117], v[118:119], v[118:119], v[116:117]
  v_pk_fma_f32 v[120:121], v[122:123], v[122:123], v[120:121]
  v_pk_add_f32 v[118:119], v[32:33], v[6:7]
  v_pk_add_f32 v[122:123], v[48:49], v[8:9]
  v_pk_fma_f32 v[116:117], v[118:119], v[118:119], v[116:117]
  v_pk_fma_f32 v[120:121], v[122:123], v[122:123], v[120:121]
  v_pk_add_f32 v[118:119], v[34:35], v[6:7]
  v_pk_add_f32 v[122:123], v[50:51], v[8:9]
  v_pk_fma_f32 v[116:117], v[118:119], v[118:119], v[116:117]
  v_pk_fma_f32 v[120:121], v[122:123], v[122:123], v[120:121]
  v_add_f32 v4, v116, v117
  v_add_f32 v5, v120, v121
  s_nop 0
  v_add_f32_dpp v4, v4, v4 quad_perm:[1,0,3,2] row_mask:0xf bank_mask:0xf
  v_add_f32_dpp v5, v5, v5 quad_perm:[1,0,3,2] row_mask:0xf bank_mask:0xf
  s_nop 0
  v_add_f32_dpp v4, v4, v4 quad_perm:[2,3,0,1] row_mask:0xf bank_mask:0xf
  v_add_f32_dpp v5, v5, v5 quad_perm:[2,3,0,1] row_mask:0xf bank_mask:0xf
  s_nop 0
  v_add_f32_dpp v4, v4, v4 row_half_mirror row_mask:0xf bank_mask:0xf
  v_add_f32_dpp v5, v5, v5 row_half_mirror row_mask:0xf bank_mask:0xf
  s_nop 0
  v_add_f32_dpp v4, v4, v4 row_mirror row_mask:0xf bank_mask:0xf
  v_add_f32_dpp v5, v5, v5 row_mirror row_mask:0xf bank_mask:0xf
  s_nop 0
  v_add_f32_dpp v4, v4, v4 row_bcast:15 row_mask:0xa bank_mask:0xf
  v_add_f32_dpp v5, v5, v5 row_bcast:15 row_mask:0xa bank_mask:0xf
  s_nop 0
  v_add_f32_dpp v4, v4, v4 row_bcast:31 row_mask:0xc bank_mask:0xf
  v_add_f32_dpp v5, v5, v5 row_bcast:31 row_mask:0xc bank_mask:0xf
  v_readlane_b32 s26, v4, 63
  v_readlane_b32 s27, v5, 63
  v_mov_b32 v4, 0x3a800000
  v_mul_f32 v4, s26, v4
  v_mov_b32 v5, 0x3a800000
  v_mul_f32 v5, s27, v5
  v_cvt_pk_bf16_f32 v4, v4, v4
  v_and_b32 v4, 0xffff0000, v4
  v_cvt_pk_bf16_f32 v5, v5, v5
  v_and_b32 v5, 0xffff0000, v5
  v_add_f32 v4, 0x3727c5ac, v4
  v_add_f32 v5, 0x3727c5ac, v5
  v_cvt_pk_bf16_f32 v4, v4, v4
  v_and_b32 v4, 0xffff0000, v4
  v_cvt_pk_bf16_f32 v5, v5, v5
  v_and_b32 v5, 0xffff0000, v5
  v_sqrt_f32 v4, v4
  v_sqrt_f32 v5, v5
  v_cvt_pk_bf16_f32 v4, v4, v4
  v_and_b32 v4, 0xffff0000, v4
  v_cvt_pk_bf16_f32 v5, v5, v5
  v_and_b32 v5, 0xffff0000, v5
  v_rcp_f32 v116, v4
  v_rcp_f32 v117, v4
  v_rcp_f32 v120, v5
  v_rcp_f32 v121, v5
  v_cvt_pk_bf16_f32 v6, v6, v6
  v_and_b32 v6, 0xffff0000, v6
  v_cvt_pk_bf16_f32 v8, v8, v8
  v_and_b32 v8, 0xffff0000, v8
  v_mov_b32 v118, v6
  v_mov_b32 v119, v6
  v_mov_b32 v122, v8
  v_mov_b32 v123, v8
  v_pk_add_f32 v[20:21], v[20:21], v[118:119]
  v_cvt_pk_bf16_f32 v21, v20, v21
  v_lshlrev_b32 v20, 16, v21
  v_and_b32 v21, 0xffff0000, v21
  v_pk_mul_f32 v[20:21], v[20:21], v[116:117]
  v_cvt_pk_bf16_f32 v4, v20, v21
  v_pk_add_f32 v[22:23], v[22:23], v[118:119]
  v_cvt_pk_bf16_f32 v23, v22, v23
  v_lshlrev_b32 v22, 16, v23
  v_and_b32 v23, 0xffff0000, v23
  v_pk_mul_f32 v[22:23], v[22:23], v[116:117]
  v_cvt_pk_bf16_f32 v5, v22, v23
  v_pk_add_f32 v[24:25], v[24:25], v[118:119]
  v_cvt_pk_bf16_f32 v25, v24, v25
  v_lshlrev_b32 v24, 16, v25
  v_and_b32 v25, 0xffff0000, v25
  v_pk_mul_f32 v[24:25], v[24:25], v[116:117]
  v_cvt_pk_bf16_f32 v6, v24, v25
  v_pk_add_f32 v[26:27], v[26:27], v[118:119]
  v_cvt_pk_bf16_f32 v27, v26, v27
  v_lshlrev_b32 v26, 16, v27
  v_and_b32 v27, 0xffff0000, v27
  v_pk_mul_f32 v[26:27], v[26:27], v[116:117]
  v_cvt_pk_bf16_f32 v7, v26, v27
  buffer_store_dwordx4 v[4:7], v3, s[12:15], s23 offen offset:0 sc1
  ds_write_b128 v180, v[4:7] offset:0
  v_pk_add_f32 v[28:29], v[28:29], v[118:119]
  v_cvt_pk_bf16_f32 v29, v28, v29
  v_lshlrev_b32 v28, 16, v29
  v_and_b32 v29, 0xffff0000, v29
  v_pk_mul_f32 v[28:29], v[28:29], v[116:117]
  v_cvt_pk_bf16_f32 v8, v28, v29
  v_pk_add_f32 v[30:31], v[30:31], v[118:119]
  v_cvt_pk_bf16_f32 v31, v30, v31
  v_lshlrev_b32 v30, 16, v31
  v_and_b32 v31, 0xffff0000, v31
  v_pk_mul_f32 v[30:31], v[30:31], v[116:117]
  v_cvt_pk_bf16_f32 v9, v30, v31
  v_pk_add_f32 v[32:33], v[32:33], v[118:119]
  v_cvt_pk_bf16_f32 v33, v32, v33
  v_lshlrev_b32 v32, 16, v33
  v_and_b32 v33, 0xffff0000, v33
  v_pk_mul_f32 v[32:33], v[32:33], v[116:117]
  v_cvt_pk_bf16_f32 v10, v32, v33
  v_pk_add_f32 v[34:35], v[34:35], v[118:119]
  v_cvt_pk_bf16_f32 v35, v34, v35
  v_lshlrev_b32 v34, 16, v35
  v_and_b32 v35, 0xffff0000, v35
  v_pk_mul_f32 v[34:35], v[34:35], v[116:117]
  v_cvt_pk_bf16_f32 v11, v34, v35
  buffer_store_dwordx4 v[8:11], v3, s[12:15], s23 offen offset:1024 sc1
  ds_write_b128 v180, v[8:11] offset:1024
  v_pk_add_f32 v[36:37], v[36:37], v[122:123]
  v_cvt_pk_bf16_f32 v37, v36, v37
  v_lshlrev_b32 v36, 16, v37
  v_and_b32 v37, 0xffff0000, v37
  v_pk_mul_f32 v[36:37], v[36:37], v[120:121]
  v_cvt_pk_bf16_f32 v12, v36, v37
  v_pk_add_f32 v[38:39], v[38:39], v[122:123]
  v_cvt_pk_bf16_f32 v39, v38, v39
  v_lshlrev_b32 v38, 16, v39
  v_and_b32 v39, 0xffff0000, v39
  v_pk_mul_f32 v[38:39], v[38:39], v[120:121]
  v_cvt_pk_bf16_f32 v13, v38, v39
  v_pk_add_f32 v[40:41], v[40:41], v[122:123]
  v_cvt_pk_bf16_f32 v41, v40, v41
  v_lshlrev_b32 v40, 16, v41
  v_and_b32 v41, 0xffff0000, v41
  v_pk_mul_f32 v[40:41], v[40:41], v[120:121]
  v_cvt_pk_bf16_f32 v14, v40, v41
  v_pk_add_f32 v[42:43], v[42:43], v[122:123]
  v_cvt_pk_bf16_f32 v43, v42, v43
  v_lshlrev_b32 v42, 16, v43
  v_and_b32 v43, 0xffff0000, v43
  v_pk_mul_f32 v[42:43], v[42:43], v[120:121]
  v_cvt_pk_bf16_f32 v15, v42, v43
  buffer_store_dwordx4 v[12:15], v3, s[12:15], s24 offen offset:0 sc1
  ds_write_b128 v180, v[12:15] offset:2048
  v_pk_add_f32 v[44:45], v[44:45], v[122:123]
  v_cvt_pk_bf16_f32 v45, v44, v45
  v_lshlrev_b32 v44, 16, v45
  v_and_b32 v45, 0xffff0000, v45
  v_pk_mul_f32 v[44:45], v[44:45], v[120:121]
  v_cvt_pk_bf16_f32 v16, v44, v45
  v_pk_add_f32 v[46:47], v[46:47], v[122:123]
  v_cvt_pk_bf16_f32 v47, v46, v47
  v_lshlrev_b32 v46, 16, v47
  v_and_b32 v47, 0xffff0000, v47
  v_pk_mul_f32 v[46:47], v[46:47], v[120:121]
  v_cvt_pk_bf16_f32 v17, v46, v47
  v_pk_add_f32 v[48:49], v[48:49], v[122:123]
  v_cvt_pk_bf16_f32 v49, v48, v49
  v_lshlrev_b32 v48, 16, v49
  v_and_b32 v49, 0xffff0000, v49
  v_pk_mul_f32 v[48:49], v[48:49], v[120:121]
  v_cvt_pk_bf16_f32 v18, v48, v49
  v_pk_add_f32 v[50:51], v[50:51], v[122:123]
  v_cvt_pk_bf16_f32 v51, v50, v51
  v_lshlrev_b32 v50, 16, v51
  v_and_b32 v51, 0xffff0000, v51
  v_pk_mul_f32 v[50:51], v[50:51], v[120:121]
  v_cvt_pk_bf16_f32 v19, v50, v51
  buffer_store_dwordx4 v[16:19], v3, s[12:15], s24 offen offset:1024 sc1
  ds_write_b128 v180, v[16:19] offset:3072
  s_waitcnt lgkmcnt(0)
  ds_read_b64_tr_b16 v[20:21], v181 offset:0
  ds_read_b64_tr_b16 v[22:23], v181 offset:512
  ds_read_b64_tr_b16 v[24:25], v181 offset:1024
  ds_read_b64_tr_b16 v[26:27], v181 offset:1536
  ds_read_b64_tr_b16 v[36:37], v181 offset:2048
  ds_read_b64_tr_b16 v[38:39], v181 offset:2560
  ds_read_b64_tr_b16 v[40:41], v181 offset:3072
  ds_read_b64_tr_b16 v[42:43], v181 offset:3584
  s_waitcnt lgkmcnt(0)
  v_mfma_f32_32x32x16_bf16 v[116:131], v[20:23], v[52:55], 0
  v_mfma_f32_32x32x16_bf16 v[132:147], v[20:23], v[60:63], 0
  v_mfma_f32_32x32x16_bf16 v[116:131], v[24:27], v[56:59], v[116:131]
  v_mfma_f32_32x32x16_bf16 v[132:147], v[24:27], v[64:67], v[132:147]
  v_mfma_f32_32x32x16_bf16 v[148:163], v[36:39], v[52:55], 0
  v_mfma_f32_32x32x16_bf16 v[164:179], v[36:39], v[60:63], 0
  v_mfma_f32_32x32x16_bf16 v[148:163], v[40:43], v[56:59], v[148:163]
  v_mfma_f32_32x32x16_bf16 v[164:179], v[40:43], v[64:67], v[164:179]
  s_nop 6
  v_pk_add_f32 v[184:185], v[116:117], v[118:119]
  v_pk_add_f32 v[184:185], v[184:185], v[120:121]
  v_pk_add_f32 v[184:185], v[184:185], v[122:123]
  v_pk_add_f32 v[184:185], v[184:185], v[124:125]
  v_pk_add_f32 v[184:185], v[184:185], v[126:127]
  v_pk_add_f32 v[184:185], v[184:185], v[128:129]
  v_pk_add_f32 v[184:185], v[184:185], v[130:131]
  v_sub_f32 v187, v184, v185
  s_nop 0
  v_readlane_b32 s28, v187, 32
  v_pk_mul_f32 v[184:185], v[116:117], v[100:101]
  v_pk_mul_f32 v[116:117], v[116:117], v[84:85]
  v_pk_fma_f32 v[116:117], v[132:133], v[100:101], v[116:117] neg_lo:[1,0,0] neg_hi:[1,0,0]
  v_pk_fma_f32 v[132:133], v[132:133], v[84:85], v[184:185]
  v_pk_mul_f32 v[184:185], v[118:119], v[102:103]
  v_pk_mul_f32 v[118:119], v[118:119], v[86:87]
  v_pk_fma_f32 v[118:119], v[134:135], v[102:103], v[118:119] neg_lo:[1,0,0] neg_hi:[1,0,0]
  v_pk_fma_f32 v[134:135], v[134:135], v[86:87], v[184:185]
  v_pk_mul_f32 v[184:185], v[120:121], v[104:105]
  v_pk_mul_f32 v[120:121], v[120:121], v[88:89]
  v_pk_fma_f32 v[120:121], v[136:137], v[104:105], v[120:121] neg_lo:[1,0,0] neg_hi:[1,0,0]
  v_pk_fma_f32 v[136:137], v[136:137], v[88:89], v[184:185]
  v_pk_mul_f32 v[184:185], v[122:123], v[106:107]
  v_pk_mul_f32 v[122:123], v[122:123], v[90:91]
  v_pk_fma_f32 v[122:123], v[138:139], v[106:107], v[122:123] neg_lo:[1,0,0] neg_hi:[1,0,0]
  v_pk_fma_f32 v[138:139], v[138:139], v[90:91], v[184:185]
  v_pk_mul_f32 v[184:185], v[124:125], v[108:109]
  v_pk_mul_f32 v[124:125], v[124:125], v[92:93]
  v_pk_fma_f32 v[124:125], v[140:141], v[108:109], v[124:125] neg_lo:[1,0,0] neg_hi:[1,0,0]
  v_pk_fma_f32 v[140:141], v[140:141], v[92:93], v[184:185]
  v_pk_mul_f32 v[184:185], v[126:127], v[110:111]
  v_pk_mul_f32 v[126:127], v[126:127], v[94:95]
  v_pk_fma_f32 v[126:127], v[142:143], v[110:111], v[126:127] neg_lo:[1,0,0] neg_hi:[1,0,0]
  v_pk_fma_f32 v[142:143], v[142:143], v[94:95], v[184:185]
  v_pk_mul_f32 v[184:185], v[128:129], v[112:113]
  v_pk_mul_f32 v[128:129], v[128:129], v[96:97]
  v_pk_fma_f32 v[128:129], v[144:145], v[112:113], v[128:129] neg_lo:[1,0,0] neg_hi:[1,0,0]
  v_pk_fma_f32 v[144:145], v[144:145], v[96:97], v[184:185]
  v_pk_mul_f32 v[184:185], v[130:131], v[114:115]
  v_pk_mul_f32 v[130:131], v[130:131], v[98:99]
  v_pk_fma_f32 v[130:131], v[146:147], v[114:115], v[130:131] neg_lo:[1,0,0] neg_hi:[1,0,0]
  v_pk_fma_f32 v[146:147], v[146:147], v[98:99], v[184:185]
  v_add_f32 v187, s28, v187
  v_cvt_pk_bf16_f32 v20, v116, v117
  v_cvt_pk_bf16_f32 v28, v132, v133
  v_cvt_pk_bf16_f32 v21, v118, v119
  v_cvt_pk_bf16_f32 v29, v134, v135
  v_cvt_pk_bf16_f32 v22, v120, v121
  v_cvt_pk_bf16_f32 v30, v136, v137
  v_cvt_pk_bf16_f32 v23, v122, v123
  v_cvt_pk_bf16_f32 v31, v138, v139
  v_cvt_pk_bf16_f32 v24, v124, v125
  v_cvt_pk_bf16_f32 v32, v140, v141
  v_cvt_pk_bf16_f32 v25, v126, v127
  v_cvt_pk_bf16_f32 v33, v142, v143
  v_cvt_pk_bf16_f32 v26, v128, v129
  v_cvt_pk_bf16_f32 v34, v144, v145
  v_cvt_pk_bf16_f32 v27, v130, v131
  v_cvt_pk_bf16_f32 v35, v146, v147
  v_mfma_f32_32x32x16_bf16 v[116:131], v[68:71], v[20:23], 0
  v_mfma_f32_32x32x16_bf16 v[116:131], v[72:75], v[24:27], v[116:131]
  v_mfma_f32_32x32x16_bf16 v[116:131], v[76:79], v[28:31], v[116:131]
  v_mfma_f32_32x32x16_bf16 v[116:131], v[80:83], v[32:35], v[116:131]
  v_pk_add_f32 v[184:185], v[148:149], v[150:151]
  v_pk_add_f32 v[184:185], v[184:185], v[152:153]
  v_pk_add_f32 v[184:185], v[184:185], v[154:155]
  v_pk_add_f32 v[184:185], v[184:185], v[156:157]
  v_pk_add_f32 v[184:185], v[184:185], v[158:159]
  v_pk_add_f32 v[184:185], v[184:185], v[160:161]
  v_pk_add_f32 v[184:185], v[184:185], v[162:163]
  v_sub_f32 v188, v184, v185
  s_nop 0
  v_readlane_b32 s29, v188, 32
  v_pk_mul_f32 v[184:185], v[148:149], v[100:101]
  v_pk_mul_f32 v[148:149], v[148:149], v[84:85]
  v_pk_fma_f32 v[148:149], v[164:165], v[100:101], v[148:149] neg_lo:[1,0,0] neg_hi:[1,0,0]
  v_pk_fma_f32 v[164:165], v[164:165], v[84:85], v[184:185]
  v_pk_mul_f32 v[184:185], v[150:151], v[102:103]
  v_pk_mul_f32 v[150:151], v[150:151], v[86:87]
  v_pk_fma_f32 v[150:151], v[166:167], v[102:103], v[150:151] neg_lo:[1,0,0] neg_hi:[1,0,0]
  v_pk_fma_f32 v[166:167], v[166:167], v[86:87], v[184:185]
  v_pk_mul_f32 v[184:185], v[152:153], v[104:105]
  v_pk_mul_f32 v[152:153], v[152:153], v[88:89]
  v_pk_fma_f32 v[152:153], v[168:169], v[104:105], v[152:153] neg_lo:[1,0,0] neg_hi:[1,0,0]
  v_pk_fma_f32 v[168:169], v[168:169], v[88:89], v[184:185]
  v_pk_mul_f32 v[184:185], v[154:155], v[106:107]
  v_pk_mul_f32 v[154:155], v[154:155], v[90:91]
  v_pk_fma_f32 v[154:155], v[170:171], v[106:107], v[154:155] neg_lo:[1,0,0] neg_hi:[1,0,0]
  v_pk_fma_f32 v[170:171], v[170:171], v[90:91], v[184:185]
  v_pk_mul_f32 v[184:185], v[156:157], v[108:109]
  v_pk_mul_f32 v[156:157], v[156:157], v[92:93]
  v_pk_fma_f32 v[156:157], v[172:173], v[108:109], v[156:157] neg_lo:[1,0,0] neg_hi:[1,0,0]
  v_pk_fma_f32 v[172:173], v[172:173], v[92:93], v[184:185]
  v_pk_mul_f32 v[184:185], v[158:159], v[110:111]
  v_pk_mul_f32 v[158:159], v[158:159], v[94:95]
  v_pk_fma_f32 v[158:159], v[174:175], v[110:111], v[158:159] neg_lo:[1,0,0] neg_hi:[1,0,0]
  v_pk_fma_f32 v[174:175], v[174:175], v[94:95], v[184:185]
  v_pk_mul_f32 v[184:185], v[160:161], v[112:113]
  v_pk_mul_f32 v[160:161], v[160:161], v[96:97]
  v_pk_fma_f32 v[160:161], v[176:177], v[112:113], v[160:161] neg_lo:[1,0,0] neg_hi:[1,0,0]
  v_pk_fma_f32 v[176:177], v[176:177], v[96:97], v[184:185]
  v_pk_mul_f32 v[184:185], v[162:163], v[114:115]
  v_pk_mul_f32 v[162:163], v[162:163], v[98:99]
  v_pk_fma_f32 v[162:163], v[178:179], v[114:115], v[162:163] neg_lo:[1,0,0] neg_hi:[1,0,0]
  v_pk_fma_f32 v[178:179], v[178:179], v[98:99], v[184:185]
  v_add_f32 v188, s29, v188
  v_cvt_pk_bf16_f32 v36, v148, v149
  v_cvt_pk_bf16_f32 v44, v164, v165
  v_cvt_pk_bf16_f32 v37, v150, v151
  v_cvt_pk_bf16_f32 v45, v166, v167
  v_cvt_pk_bf16_f32 v38, v152, v153
  v_cvt_pk_bf16_f32 v46, v168, v169
  v_cvt_pk_bf16_f32 v39, v154, v155
  v_cvt_pk_bf16_f32 v47, v170, v171
  v_cvt_pk_bf16_f32 v40, v156, v157
  v_cvt_pk_bf16_f32 v48, v172, v173
  v_cvt_pk_bf16_f32 v41, v158, v159
  v_cvt_pk_bf16_f32 v49, v174, v175
  v_cvt_pk_bf16_f32 v42, v160, v161
  v_cvt_pk_bf16_f32 v50, v176, v177
  v_cvt_pk_bf16_f32 v43, v162, v163
  v_cvt_pk_bf16_f32 v51, v178, v179
  v_mfma_f32_32x32x16_bf16 v[148:163], v[68:71], v[36:39], 0
  v_mfma_f32_32x32x16_bf16 v[148:163], v[72:75], v[40:43], v[148:163]
  v_mfma_f32_32x32x16_bf16 v[148:163], v[76:79], v[44:47], v[148:163]
  v_mfma_f32_32x32x16_bf16 v[148:163], v[80:83], v[48:51], v[148:163]
  v_cmp_eq_u32 vcc, 0, v2
  v_mul_f32 v187, 0.5, v187
  v_mul_f32 v189, 0.5, v116
  v_cndmask_b32 v116, v116, v189, vcc
  v_cndmask_b32 v124, v124, v187, vcc
  v_mul_f32 v188, 0.5, v188
  s_nop 5
  v_mul_f32 v189, 0.5, v148
  v_cndmask_b32 v148, v148, v189, vcc
  v_cndmask_b32 v156, v156, v188, vcc
  v_cvt_pk_bf16_f32 v20, v116, v148
  v_cvt_pk_bf16_f32 v21, v124, v156
  ds_write_b64 v182, v[20:21] offset:0
  v_cvt_pk_bf16_f32 v22, v117, v149
  v_cvt_pk_bf16_f32 v23, v125, v157
  ds_write_b64 v182, v[22:23] offset:256
  v_cvt_pk_bf16_f32 v24, v118, v150
  v_cvt_pk_bf16_f32 v25, v126, v158
  ds_write_b64 v182, v[24:25] offset:512
  v_cvt_pk_bf16_f32 v26, v119, v151
  v_cvt_pk_bf16_f32 v27, v127, v159
  ds_write_b64 v182, v[26:27] offset:768
  v_cvt_pk_bf16_f32 v28, v120, v152
  v_cvt_pk_bf16_f32 v29, v128, v160
  ds_write_b64 v182, v[28:29] offset:2048
  v_cvt_pk_bf16_f32 v30, v121, v153
  v_cvt_pk_bf16_f32 v31, v129, v161
  ds_write_b64 v182, v[30:31] offset:2304
  v_cvt_pk_bf16_f32 v32, v122, v154
  v_cvt_pk_bf16_f32 v33, v130, v162
  ds_write_b64 v182, v[32:33] offset:2560
  v_cvt_pk_bf16_f32 v34, v123, v155
  v_cvt_pk_bf16_f32 v35, v131, v163
  ds_write_b64 v182, v[34:35] offset:2816
  s_lshr_b32 s87, s2, 6
  s_lshl_b32 s87, s87, 9
  s_and_b32 s86, s2, 63
  s_add_u32 s87, s87, s86
  s_lshl_b32 s87, s87, 4
  s_add_u32 s87, s87, 131072
  s_add_u32 s88, s88, 0x9e3779b1
  v_mov_b32 v8, s88
  v_mov_b32 v9, s88
  v_mov_b32 v10, s88
  v_mov_b32 v11, s88
  v_lshlrev_b32 v15, 10, v2
  s_waitcnt vmcnt(0) lgkmcnt(0)
  s_barrier
  s_cmp_lg_u32 s20, 0
  s_cbranch_scc1 p0_s
  s_mov_b64 exec, 0xff
  buffer_store_dwordx4 v[8:11], v15, s[92:95], s87 offen sc1
  s_mov_b64 exec, -1
p0_s:
  s_add_u32 s44, s90, 0x400000
  s_addc_u32 s45, s91, 0
  s_mov_b32 s46, 0x400000
  s_mov_b32 s47, 0x20000
  v_lshlrev_b32 v16, 2, v0
  v_add_u32 v16, 0x20000, v16
  v_lshlrev_b32 v17, 4, v0
  s_lshl_b32 s23, s2, 14
  ds_read2st64_b32 v[36:37], v16 offset0:0 offset1:16
  ds_read2st64_b32 v[38:39], v16 offset0:32 offset1:48
  ds_read2st64_b32 v[40:41], v16 offset0:4 offset1:20
  ds_read2st64_b32 v[42:43], v16 offset0:36 offset1:52
  ds_read2st64_b32 v[44:45], v16 offset0:8 offset1:24
  ds_read2st64_b32 v[46:47], v16 offset0:40 offset1:56
  ds_read2st64_b32 v[48:49], v16 offset0:12 offset1:28
  ds_read2st64_b32 v[50:51], v16 offset0:44 offset1:60
  s_waitcnt lgkmcnt(6)
  buffer_store_dwordx4 v[36:39], v17, s[44:47], s23 offen sc1
  s_add_u32 s23, s23, 4096
  s_waitcnt lgkmcnt(4)
  buffer_store_dwordx4 v[40:43], v17, s[44:47], s23 offen sc1
  s_add_u32 s23, s23, 4096
  s_waitcnt lgkmcnt(2)
  buffer_store_dwordx4 v[44:47], v17, s[44:47], s23 offen sc1
  s_add_u32 s23, s23, 4096
  s_waitcnt lgkmcnt(0)
  buffer_store_dwordx4 v[48:51], v17, s[44:47], s23 offen sc1
  s_add_u32 s23, s23, 4096
  s_branch p0_j
p0_w:
  s_mov_b32 s36, s32
  s_mov_b32 s37, s33
  s_mov_b32 s38, 0x201000
  s_mov_b32 s39, 0x20000
  s_mov_b32 s40, s34
  s_mov_b32 s41, s35
  s_mov_b32 s42, 0x201000
  s_mov_b32 s43, 0x20000
  s_add_u32 s44, s90, 0x2400000
  s_addc_u32 s45, s91, 0
  s_mov_b32 s46, 0x800000
  s_mov_b32 s47, 0x20000
  s_lshr_b32 s30, s2, 5
  s_lshl_b32 s30, s30, 8
  s_and_b32 s31, s2, 31
  s_add_u32 s30, s30, s31
  s_mul_i32 s30, s30, 1026
  s_lshl_b32 s31, s2, 14
  s_mov_b32 s48, 0x05040100
  s_mov_b32 s49, 0x07060302
  v_and_b32 v189, 255, v0
  v_lshrrev_b32 v190, 7, v189
  v_and_b32 v191, 127, v189
  v_mul_u32_u24 v192, 131328, v190
  v_lshl_add_u32 v192, v191, 3, v192
  v_lshlrev_b32 v190, 13, v190
  v_lshl_add_u32 v190, v191, 6, v190
  v_mul_u32_u24 v193, 32832, v189
  v_add_u32 v193, 1024, v193
  v_lshrrev_b32 v191, 2, v189
  v_lshlrev_b32 v191, 13, v191
  v_and_b32 v194, 3, v189
  v_lshl_add_u32 v191, v194, 1, v191
  v_add_u32 v191, 4194304, v191
  v_cmp_gt_u32 vcc, 8, v189
  v_mov_b32 v194, 0x7fffffff
  s_nop 0
  v_cndmask_b32 v193, v194, v193, vcc
  v_cndmask_b32 v191, v194, v191, vcc
  buffer_load_ushort v194, v193, s[36:39], s30 offen
  buffer_load_ushort v195, v193, s[40:43], s30 offen
  buffer_load_dwordx2 v[196:197], v192, s[36:39], s30 offen
  buffer_load_dwordx2 v[204:205], v192, s[40:43], s30 offen
  s_add_u32 s30, s30, 32832
  buffer_load_dwordx2 v[198:199], v192, s[36:39], s30 offen
  buffer_load_dwordx2 v[206:207], v192, s[40:43], s30 offen
  s_add_u32 s30, s30, 32832
  buffer_load_dwordx2 v[200:201], v192, s[36:39], s30 offen
  buffer_load_dwordx2 v[208:209], v192, s[40:43], s30 offen
  s_add_u32 s30, s30, 32832
  buffer_load_dwordx2 v[202:203], v192, s[36:39], s30 offen
  buffer_load_dwordx2 v[210:211], v192, s[40:43], s30 offen
  s_add_u32 s30, s30, 32832
  s_waitcnt vmcnt(0)
  s_cmp_lg_u32 s20, 4
  s_cbranch_scc1 wr_ns
  s_mov_b64 exec, 0xff
  buffer_store_short v194, v191, s[44:47], s31 offen sc1
  buffer_store_short v195, v191, s[44:47], s31 offen offset:8 sc1
  s_mov_b64 exec, -1
wr_ns:
  v_add_u32 v192, 0x24000, v190
  v_and_b32 v190, 0x3000, v190
  v_lshl_add_u32 v190, v2, 4, v190
  v_add_u32 v193, 0x24000, v190
  v_perm_b32 v212, v198, v196, s48
  v_perm_b32 v213, v202, v200, s48
  v_perm_b32 v214, v206, v204, s48
  v_perm_b32 v215, v210, v208, s48
  ds_write_b128 v192, v[212:215] offset:0
  v_perm_b32 v216, v198, v196, s49
  v_perm_b32 v217, v202, v200, s49
  v_perm_b32 v218, v206, v204, s49
  v_perm_b32 v219, v210, v208, s49
  ds_write_b128 v192, v[216:219] offset:16
  v_perm_b32 v220, v199, v197, s48
  v_perm_b32 v221, v203, v201, s48
  v_perm_b32 v222, v207, v205, s48
  v_perm_b32 v223, v211, v209, s48
  ds_write_b128 v192, v[220:223] offset:32
  v_perm_b32 v224, v199, v197, s49
  v_perm_b32 v225, v203, v201, s49
  v_perm_b32 v226, v207, v205, s49
  v_perm_b32 v227, v211, v209, s49
  ds_write_b128 v192, v[224:227] offset:48
  s_waitcnt lgkmcnt(0)
  ds_read_b128 v[196:199], v193 offset:0
  ds_read_b128 v[200:203], v193 offset:1024
  ds_read_b128 v[204:207], v193 offset:2048
  ds_read_b128 v[208:211], v193 offset:3072
  s_waitcnt lgkmcnt(3)
  buffer_store_dwordx4 v[196:199], v190, s[44:47], s31 offen offset:0 sc1
  s_waitcnt lgkmcnt(2)
  buffer_store_dwordx4 v[200:203], v190, s[44:47], s31 offen offset:1024 sc1
  s_waitcnt lgkmcnt(1)
  buffer_store_dwordx4 v[204:207], v190, s[44:47], s31 offen offset:2048 sc1
  s_waitcnt lgkmcnt(0)
  buffer_store_dwordx4 v[208:211], v190, s[44:47], s31 offen offset:3072 sc1
  s_add_u32 s88, s88, 0x9e3779b1
  s_barrier
  s_and_b32 s3, s2, 7
  s_lshr_b32 s4, s2, 3
  s_and_b32 s21, s3, 1
  s_lshl_b32 s21, s21, 2
  s_and_b32 s23, s4, 3
  s_add_u32 s21, s21, s23
  s_lshr_b32 s22, s3, 1
  s_mul_i32 s22, s22, 7
  s_lshr_b32 s23, s4, 2
  s_add_u32 s22, s22, s23
  s_load_dwordx4 s[4:7], s[0:1], 32
  s_load_dwordx2 s[24:25], s[0:1], 72
  v_lshrrev_b32 v3, 2, v2
  v_lshl_add_u32 v3, v1, 5, v3
  v_lshlrev_b32 v3, 11, v3
  v_lshrrev_b32 v4, 4, v2
  v_sub_u32 v5, 0, v4
  v_xor_b32 v5, v5, v2
  v_and_b32 v5, 3, v5
  v_lshl_add_u32 v3, v5, 4, v3
  v_lshl_add_u32 v5, v1, 2, v4
  v_bfe_u32 v6, v5, 3, 1
  v_lshl_add_u32 v6, v6, 2, v4
  v_mul_u32_u24 v5, 0x1c00, v5
  v_lshlrev_b32 v6, 1, v6
  v_xor_b32 v6, v6, v2
  v_and_b32 v6, 15, v6
  v_lshl_add_u32 v4, v6, 4, v5
  s_lshl_b32 s26, s21, 19
  s_lshl_b32 s28, s22, 8
  s_lshl_b32 s29, s20, 11
  s_lshl_b32 s30, s20, 10
  v_add_u32 v112, 32768, v3
  s_waitcnt lgkmcnt(0)
  s_mov_b32 s8, s24
  s_mov_b32 s9, s25
  s_mov_b32 s10, 0x400000
  s_mov_b32 s11, 0x20000
  s_mov_b32 s12, s4
  s_mov_b32 s13, s5
  s_mov_b32 s14, 0x700000
  s_mov_b32 s15, 0x20000
  s_mov_b32 s16, s6
  s_mov_b32 s17, s7
  s_mov_b32 s18, 0x700000
  s_mov_b32 s19, 0x20000
  s_add_u32 s32, s24, 0x800000
  s_addc_u32 s33, s25, 0
  s_mov_b32 s34, 0xe00000
  s_mov_b32 s35, 0x20000
  s_cmp_ge_u32 s2, 224
  s_cbranch_scc1 p0_f
  v_subrev_u32 v5, 114688, v4
  s_add_u32 m0, s30, 16384
  s_nop 0
  buffer_load_dwordx4 v4, s[12:15], s28 offen lds
  s_add_u32 m0, s30, 12288
  s_nop 0
  buffer_load_dwordx4 v5, s[12:15], s28 offen lds
  s_add_u32 m0, s30, 24576
  s_nop 0
  buffer_load_dwordx4 v4, s[16:19], s28 offen lds
  s_add_u32 m0, s30, 20480
  s_nop 0
  buffer_load_dwordx4 v5, s[16:19], s28 offen lds
  s_add_u32 s28, s28, 229376
  s_add_u32 m0, s30, 49152
  s_nop 0
  buffer_load_dwordx4 v4, s[12:15], s28 offen lds
  s_add_u32 m0, s30, 45056
  s_nop 0
  buffer_load_dwordx4 v5, s[12:15], s28 offen lds
  s_add_u32 m0, s30, 57344
  s_nop 0
  buffer_load_dwordx4 v4, s[16:19], s28 offen lds
  s_add_u32 m0, s30, 53248
  s_nop 0
  buffer_load_dwordx4 v5, s[16:19], s28 offen lds
  s_add_u32 s28, s28, 229376
  s_add_u32 m0, s30, 81920
  s_nop 0
  buffer_load_dwordx4 v4, s[12:15], s28 offen lds
  s_add_u32 m0, s30, 77824
  s_nop 0
  buffer_load_dwordx4 v5, s[12:15], s28 offen lds
  s_add_u32 m0, s30, 90112
  s_nop 0
  buffer_load_dwordx4 v4, s[16:19], s28 offen lds
  s_add_u32 m0, s30, 86016
  s_nop 0
  buffer_load_dwordx4 v5, s[16:19], s28 offen lds
  s_add_u32 s28, s28, 229376
  s_add_u32 m0, s30, 114688
  s_nop 0
  buffer_load_dwordx4 v4, s[12:15], s28 offen lds
  s_add_u32 m0, s30, 110592
  s_nop 0
  buffer_load_dwordx4 v5, s[12:15], s28 offen lds
  s_add_u32 m0, s30, 122880
  s_nop 0
  buffer_load_dwordx4 v4, s[16:19], s28 offen lds
  s_add_u32 m0, s30, 118784
  s_nop 0
  buffer_load_dwordx4 v5, s[16:19], s28 offen lds
  s_add_u32 s28, s28, 229376
  s_waitcnt vmcnt(16)
p0_f:
p0_j:
  s_cmp_ge_u32 s2, 224
  s_cbranch_scc1 k1_fft
  s_and_b32 s3, s2, 7
  s_lshr_b32 s4, s2, 3
  s_and_b32 s21, s3, 1
  s_lshl_b32 s21, s21, 2
  s_and_b32 s23, s4, 3
  s_add_u32 s21, s21, s23
  s_lshr_b32 s22, s3, 1
  s_mul_i32 s22, s22, 7
  s_lshr_b32 s23, s4, 2
  s_add_u32 s22, s22, s23
  s_load_dwordx4 s[4:7], s[0:1], 32
  s_load_dwordx2 s[24:25], s[0:1], 72
  v_lshrrev_b32 v3, 2, v2
  v_lshl_add_u32 v3, v1, 5, v3
  v_lshlrev_b32 v3, 11, v3
  v_lshrrev_b32 v4, 4, v2
  v_sub_u32 v5, 0, v4
  v_xor_b32 v5, v5, v2
  v_and_b32 v5, 3, v5
  v_lshl_add_u32 v3, v5, 4, v3
  v_lshl_add_u32 v5, v1, 2, v4
  v_bfe_u32 v6, v5, 3, 1
  v_lshl_add_u32 v6, v6, 2, v4
  v_mul_u32_u24 v5, 0x1c00, v5
  v_lshlrev_b32 v6, 1, v6
  v_xor_b32 v6, v6, v2
  v_and_b32 v6, 15, v6
  v_lshl_add_u32 v4, v6, 4, v5
  s_lshl_b32 s26, s21, 19
  s_lshl_b32 s28, s22, 8
  s_lshl_b32 s29, s20, 11
  s_lshl_b32 s30, s20, 10
  v_add_u32 v112, 32768, v3
  s_waitcnt lgkmcnt(0)
  s_mov_b32 s8, s24
  s_mov_b32 s9, s25
  s_mov_b32 s10, 0x400000
  s_mov_b32 s11, 0x20000
  s_mov_b32 s12, s4
  s_mov_b32 s13, s5
  s_mov_b32 s14, 0x700000
  s_mov_b32 s15, 0x20000
  s_mov_b32 s16, s6
  s_mov_b32 s17, s7
  s_mov_b32 s18, 0x700000
  s_mov_b32 s19, 0x20000
  s_add_u32 s32, s24, 0x800000
  s_addc_u32 s33, s25, 0
  s_mov_b32 s34, 0xe00000
  s_mov_b32 s35, 0x20000
  s_add_u32 s28, s28, 917504
  v_and_b32 v5, 15, v2
  v_lshrrev_b32 v12, 2, v1
  v_lshl_add_u32 v5, v12, 7, v5
  v_lshlrev_b32 v5, 6, v5
  v_lshrrev_b32 v12, 4, v2
  v_bfe_u32 v13, v2, 2, 2
  v_sub_u32 v14, 0, v13
  v_xor_b32 v14, v12, v14
  v_and_b32 v14, 3, v14
  v_lshl_add_u32 v6, v14, 4, v5
  v_lshl_add_u32 v5, v12, 3, v13
  v_lshlrev_b32 v5, 8, v5
  v_and_b32 v14, 1, v12
  v_lshl_add_u32 v14, v14, 2, v13
  v_and_b32 v15, 3, v1
  v_lshlrev_b32 v15, 1, v15
  v_xor_b32 v14, v14, v15
  v_lshl_add_u32 v5, v14, 5, v5
  v_and_b32 v14, 3, v2
  v_lshl_add_u32 v5, v14, 3, v5
  v_add_u32 v7, 0x4000, v5
  v_xor_b32 v8, 32, v7
  v_add_u32 v116, 0x10000, v6
  v_add_u32 v117, 0x10000, v7
  v_add_u32 v118, 0x10000, v8
  v_mov_b32 v128, 0
  v_mov_b32 v129, 0
  v_mov_b32 v130, 0
  v_mov_b32 v131, 0
  v_mov_b32 v132, 0
  v_mov_b32 v133, 0
  v_mov_b32 v134, 0
  v_mov_b32 v135, 0
  v_mov_b32 v136, 0
  v_mov_b32 v137, 0
  v_mov_b32 v138, 0
  v_mov_b32 v139, 0
  v_mov_b32 v140, 0
  v_mov_b32 v141, 0
  v_mov_b32 v142, 0
  v_mov_b32 v143, 0
  v_mov_b32 v144, 0
  v_mov_b32 v145, 0
  v_mov_b32 v146, 0
  v_mov_b32 v147, 0
  v_mov_b32 v148, 0
  v_mov_b32 v149, 0
  v_mov_b32 v150, 0
  v_mov_b32 v151, 0
  v_mov_b32 v152, 0
  v_mov_b32 v153, 0
  v_mov_b32 v154, 0
  v_mov_b32 v155, 0
  v_mov_b32 v156, 0
  v_mov_b32 v157, 0
  v_mov_b32 v158, 0
  v_mov_b32 v159, 0
  v_mov_b32 v160, 0
  v_mov_b32 v161, 0
  v_mov_b32 v162, 0
  v_mov_b32 v163, 0
  v_mov_b32 v164, 0
  v_mov_b32 v165, 0
  v_mov_b32 v166, 0
  v_mov_b32 v167, 0
  v_mov_b32 v168, 0
  v_mov_b32 v169, 0
  v_mov_b32 v170, 0
  v_mov_b32 v171, 0
  v_mov_b32 v172, 0
  v_mov_b32 v173, 0
  v_mov_b32 v174, 0
  v_mov_b32 v175, 0
  v_mov_b32 v176, 0
  v_mov_b32 v177, 0
  v_mov_b32 v178, 0
  v_mov_b32 v179, 0
  v_mov_b32 v180, 0
  v_mov_b32 v181, 0
  v_mov_b32 v182, 0
  v_mov_b32 v183, 0
  v_mov_b32 v184, 0
  v_mov_b32 v185, 0
  v_mov_b32 v186, 0
  v_mov_b32 v187, 0
  v_mov_b32 v188, 0
  v_mov_b32 v189, 0
  v_mov_b32 v190, 0
  v_mov_b32 v191, 0
  v_mov_b32 v192, 0
  v_mov_b32 v193, 0
  v_mov_b32 v194, 0
  v_mov_b32 v195, 0
  v_mov_b32 v196, 0
  v_mov_b32 v197, 0
  v_mov_b32 v198, 0
  v_mov_b32 v199, 0
  v_mov_b32 v200, 0
  v_mov_b32 v201, 0
  v_mov_b32 v202, 0
  v_mov_b32 v203, 0
  v_mov_b32 v204, 0
  v_mov_b32 v205, 0
  v_mov_b32 v206, 0
  v_mov_b32 v207, 0
  v_mov_b32 v208, 0
  v_mov_b32 v209, 0
  v_mov_b32 v210, 0
  v_mov_b32 v211, 0
  v_mov_b32 v212, 0
  v_mov_b32 v213, 0
  v_mov_b32 v214, 0
  v_mov_b32 v215, 0
  v_mov_b32 v216, 0
  v_mov_b32 v217, 0
  v_mov_b32 v218, 0
  v_mov_b32 v219, 0
  v_mov_b32 v220, 0
  v_mov_b32 v221, 0
  v_mov_b32 v222, 0
  v_mov_b32 v223, 0
  v_mov_b32 v224, 0
  v_mov_b32 v225, 0
  v_mov_b32 v226, 0
  v_mov_b32 v227, 0
  v_mov_b32 v228, 0
  v_mov_b32 v229, 0
  v_mov_b32 v230, 0
  v_mov_b32 v231, 0
  v_mov_b32 v232, 0
  v_mov_b32 v233, 0
  v_mov_b32 v234, 0
  v_mov_b32 v235, 0
  v_mov_b32 v236, 0
  v_mov_b32 v237, 0
  v_mov_b32 v238, 0
  v_mov_b32 v239, 0
  v_mov_b32 v240, 0
  v_mov_b32 v241, 0
  v_mov_b32 v242, 0
  v_mov_b32 v243, 0
  v_mov_b32 v244, 0
  v_mov_b32 v245, 0
  v_mov_b32 v246, 0
  v_mov_b32 v247, 0
  v_mov_b32 v248, 0
  v_mov_b32 v249, 0
  v_mov_b32 v250, 0
  v_mov_b32 v251, 0
  v_mov_b32 v252, 0
  v_mov_b32 v253, 0
  v_mov_b32 v254, 0
  v_mov_b32 v255, 0
  s_cmp_lt_u32 s20, 4
  s_cbranch_scc1 g1_np
  s_setprio 1
g1_np:
  s_lshr_b32 s23, s21, 2
  s_lshl_b32 s23, s23, 1
  s_and_b32 s31, s21, 1
  s_add_u32 s23, s23, s31
  s_lshl_b32 s23, s23, 3
  s_and_b32 s31, s22, 7
  s_add_u32 s23, s23, s31
  s_lshl_b32 s23, s23, 10
  s_add_u32 s23, s23, 131072
  s_load_dwordx2 s[36:37], s[0:1], 48
  s_mov_b64 s[38:39], s[14:15]
  s_lshl_b32 s41, s2, 15
  v_lshl_add_u32 v126, v1, 5, v2
  v_lshlrev_b32 v126, 7, v126
  v_bfrev_b32 v124, -2
  v_cmp_gt_u32 vcc, 32, v2
  s_nop 1
  v_cndmask_b32 v126, v124, v126, vcc
  s_waitcnt lgkmcnt(0)
  s_lshl_b32 s87, s2, 2
  s_add_u32 s87, s87, 73728
  s_cmp_ge_u32 s20, 4
  s_cbranch_scc1 g1_nw
  s_waitcnt vmcnt(0)
g1_nw:
  s_barrier
  s_cmp_lg_u32 s20, 1
  s_cbranch_scc1 g1_sx
  v_mov_b32 v14, s88
  v_lshlrev_b32 v15, 10, v2
  s_mov_b32 exec_lo, 255
  s_mov_b32 exec_hi, 0
  buffer_store_dword v14, v15, s[92:95], s87 offen sc1
  s_mov_b64 exec, -1
g1_sx:
  v_lshlrev_b32 v20, 4, v2
  s_cmp_lg_u32 s20, 0
  s_cbranch_scc1 g1_p_ok
  s_mov_b64 exec, -1
g1_p:
  buffer_load_dwordx4 v[16:19], v20, s[92:95], s23 offen sc1
  s_waitcnt vmcnt(0)
  v_xor_b32 v17, v17, v18
  v_xor_b32 v18, v18, v19
  v_xor_b32 v19, v19, v16
  v_or3_b32 v17, v17, v18, v19
  v_xor_b32 v16, s88, v16
  v_or_b32 v16, v16, v17
  v_cmp_ne_u32 vcc, 0, v16
  s_nop 4
  s_cbranch_vccnz g1_p
g1_p_ok:
  s_mov_b64 exec, -1
  s_barrier
  s_add_u32 m0, s29, 0
  s_nop 0
  buffer_load_dwordx4 v3, s[8:11], s26 offen sc1 lds
  s_add_u32 m0, s29, 1024
  s_nop 0
  buffer_load_dwordx4 v112, s[8:11], s26 offen sc1 lds
  s_add_u32 s26, s26, 64
  s_add_u32 m0, s29, 32768
  s_nop 0
  buffer_load_dwordx4 v3, s[8:11], s26 offen sc1 lds
  s_add_u32 m0, s29, 33792
  s_nop 0
  buffer_load_dwordx4 v112, s[8:11], s26 offen sc1 lds
  s_add_u32 s26, s26, 64
  s_add_u32 m0, s29, 65536
  s_nop 0
  buffer_load_dwordx4 v3, s[8:11], s26 offen sc1 lds
  s_add_u32 m0, s29, 66560
  s_nop 0
  buffer_load_dwordx4 v112, s[8:11], s26 offen sc1 lds
  s_add_u32 s26, s26, 64
  s_add_u32 m0, s29, 98304
  s_nop 0
  buffer_load_dwordx4 v3, s[8:11], s26 offen sc1 lds
  s_add_u32 m0, s29, 99328
  s_nop 0
  buffer_load_dwordx4 v112, s[8:11], s26 offen sc1 lds
  s_add_u32 s26, s26, 64
  s_waitcnt vmcnt(6)
  s_barrier
  ds_read_b64_tr_b16 v[48:49], v7 offset:0
  ds_read_b64_tr_b16 v[50:51], v7 offset:1024
  ds_read_b64_tr_b16 v[52:53], v7 offset:8192
  ds_read_b64_tr_b16 v[54:55], v7 offset:9216
  ds_read_b64_tr_b16 v[56:57], v8 offset:0
  ds_read_b64_tr_b16 v[58:59], v8 offset:1024
  ds_read_b64_tr_b16 v[60:61], v8 offset:8192
  ds_read_b64_tr_b16 v[62:63], v8 offset:9216
  ds_read_b128 v[16:19], v6 offset:0
  ds_read_b128 v[20:23], v6 offset:1024
  ds_read_b128 v[24:27], v6 offset:2048
  ds_read_b128 v[28:31], v6 offset:3072
  s_waitcnt lgkmcnt(0)
  v_mfma_f32_16x16x32_bf16 v[128:131], v[48:51], v[16:19], v[128:131]
  ds_read_b128 v[32:35], v6 offset:4096
  v_mfma_f32_16x16x32_bf16 v[132:135], v[52:55], v[16:19], v[132:135]
  ds_read_b128 v[36:39], v6 offset:5120
  v_mfma_f32_16x16x32_bf16 v[136:139], v[56:59], v[16:19], v[136:139]
  ds_read_b128 v[40:43], v6 offset:6144
  v_mfma_f32_16x16x32_bf16 v[140:143], v[60:63], v[16:19], v[140:143]
  ds_read_b128 v[44:47], v6 offset:7168
  v_mfma_f32_16x16x32_bf16 v[156:159], v[60:63], v[20:23], v[156:159]
  v_mfma_f32_16x16x32_bf16 v[152:155], v[56:59], v[20:23], v[152:155]
  v_mfma_f32_16x16x32_bf16 v[148:151], v[52:55], v[20:23], v[148:151]
  v_mfma_f32_16x16x32_bf16 v[144:147], v[48:51], v[20:23], v[144:147]
  v_mfma_f32_16x16x32_bf16 v[160:163], v[48:51], v[24:27], v[160:163]
  v_mfma_f32_16x16x32_bf16 v[164:167], v[52:55], v[24:27], v[164:167]
  v_mfma_f32_16x16x32_bf16 v[168:171], v[56:59], v[24:27], v[168:171]
  v_mfma_f32_16x16x32_bf16 v[172:175], v[60:63], v[24:27], v[172:175]
  v_mfma_f32_16x16x32_bf16 v[188:191], v[60:63], v[28:31], v[188:191]
  v_mfma_f32_16x16x32_bf16 v[184:187], v[56:59], v[28:31], v[184:187]
  v_mfma_f32_16x16x32_bf16 v[180:183], v[52:55], v[28:31], v[180:183]
  v_mfma_f32_16x16x32_bf16 v[176:179], v[48:51], v[28:31], v[176:179]
  s_waitcnt vmcnt(2) lgkmcnt(0)
  s_barrier
  v_mfma_f32_16x16x32_bf16 v[192:195], v[48:51], v[32:35], v[192:195]
  ds_read_b64_tr_b16 v[64:65], v7 offset:32768
  v_mfma_f32_16x16x32_bf16 v[196:199], v[52:55], v[32:35], v[196:199]
  ds_read_b64_tr_b16 v[66:67], v7 offset:33792
  v_mfma_f32_16x16x32_bf16 v[200:203], v[56:59], v[32:35], v[200:203]
  ds_read_b64_tr_b16 v[68:69], v7 offset:40960
  v_mfma_f32_16x16x32_bf16 v[204:207], v[60:63], v[32:35], v[204:207]
  ds_read_b64_tr_b16 v[70:71], v7 offset:41984
  v_mfma_f32_16x16x32_bf16 v[220:223], v[60:63], v[36:39], v[220:223]
  ds_read_b128 v[16:19], v6 offset:32768
  v_mfma_f32_16x16x32_bf16 v[216:219], v[56:59], v[36:39], v[216:219]
  ds_read_b64_tr_b16 v[72:73], v8 offset:32768
  v_mfma_f32_16x16x32_bf16 v[212:215], v[52:55], v[36:39], v[212:215]
  ds_read_b64_tr_b16 v[74:75], v8 offset:33792
  v_mfma_f32_16x16x32_bf16 v[208:211], v[48:51], v[36:39], v[208:211]
  ds_read_b64_tr_b16 v[76:77], v8 offset:40960
  v_mfma_f32_16x16x32_bf16 v[224:227], v[48:51], v[40:43], v[224:227]
  ds_read_b64_tr_b16 v[78:79], v8 offset:41984
  v_mfma_f32_16x16x32_bf16 v[228:231], v[52:55], v[40:43], v[228:231]
  ds_read_b128 v[20:23], v6 offset:33792
  v_mfma_f32_16x16x32_bf16 v[232:235], v[56:59], v[40:43], v[232:235]
  ds_read_b128 v[24:27], v6 offset:34816
  v_mfma_f32_16x16x32_bf16 v[236:239], v[60:63], v[40:43], v[236:239]
  ds_read_b128 v[28:31], v6 offset:35840
  v_mfma_f32_16x16x32_bf16 v[252:255], v[60:63], v[44:47], v[252:255]
  v_mfma_f32_16x16x32_bf16 v[248:251], v[56:59], v[44:47], v[248:251]
  v_mfma_f32_16x16x32_bf16 v[244:247], v[52:55], v[44:47], v[244:247]
  v_mfma_f32_16x16x32_bf16 v[240:243], v[48:51], v[44:47], v[240:243]
  s_mov_b32 s31, 7
.p2align 3
g1_loop:
  s_cmp_lg_u32 s31, 2
  s_cbranch_scc1 g1_pf
  buffer_load_dword v124, v126, s[36:39], s41 offen
g1_pf:
  s_waitcnt lgkmcnt(0)
  v_mfma_f32_16x16x32_bf16 v[128:131], v[64:67], v[16:19], v[128:131]
  ds_read_b128 v[32:35], v6 offset:36864
  v_mfma_f32_16x16x32_bf16 v[132:135], v[68:71], v[16:19], v[132:135]
  ds_read_b128 v[36:39], v6 offset:37888
  v_mfma_f32_16x16x32_bf16 v[136:139], v[72:75], v[16:19], v[136:139]
  ds_read_b128 v[40:43], v6 offset:38912
  v_mfma_f32_16x16x32_bf16 v[140:143], v[76:79], v[16:19], v[140:143]
  ds_read_b128 v[44:47], v6 offset:39936
  v_mfma_f32_16x16x32_bf16 v[156:159], v[76:79], v[20:23], v[156:159]
  s_add_u32 m0, s30, 16384
  v_mfma_f32_16x16x32_bf16 v[152:155], v[72:75], v[20:23], v[152:155]
  buffer_load_dwordx4 v4, s[12:15], s28 offen lds
  v_mfma_f32_16x16x32_bf16 v[148:151], v[68:71], v[20:23], v[148:151]
  s_add_u32 m0, s29, 0
  v_mfma_f32_16x16x32_bf16 v[144:147], v[64:67], v[20:23], v[144:147]
  buffer_load_dwordx4 v3, s[8:11], s26 offen sc1 lds
  v_mfma_f32_16x16x32_bf16 v[160:163], v[64:67], v[24:27], v[160:163]
  v_mfma_f32_16x16x32_bf16 v[164:167], v[68:71], v[24:27], v[164:167]
  s_add_u32 m0, s30, 24576
  v_mfma_f32_16x16x32_bf16 v[168:171], v[72:75], v[24:27], v[168:171]
  buffer_load_dwordx4 v4, s[16:19], s28 offen lds
  s_add_u32 s28, s28, 229376
  v_mfma_f32_16x16x32_bf16 v[172:175], v[76:79], v[24:27], v[172:175]
  v_mfma_f32_16x16x32_bf16 v[188:191], v[76:79], v[28:31], v[188:191]
  s_add_u32 m0, s29, 1024
  v_mfma_f32_16x16x32_bf16 v[184:187], v[72:75], v[28:31], v[184:187]
  buffer_load_dwordx4 v112, s[8:11], s26 offen sc1 lds
  s_add_u32 s26, s26, 64
  v_mfma_f32_16x16x32_bf16 v[180:183], v[68:71], v[28:31], v[180:183]
  v_mfma_f32_16x16x32_bf16 v[176:179], v[64:67], v[28:31], v[176:179]
  s_waitcnt vmcnt(8) lgkmcnt(0)
  s_barrier
  v_mfma_f32_16x16x32_bf16 v[192:195], v[64:67], v[32:35], v[192:195]
  ds_read_b64_tr_b16 v[48:49], v117 offset:0
  v_mfma_f32_16x16x32_bf16 v[196:199], v[68:71], v[32:35], v[196:199]
  ds_read_b64_tr_b16 v[50:51], v117 offset:1024
  v_mfma_f32_16x16x32_bf16 v[200:203], v[72:75], v[32:35], v[200:203]
  ds_read_b64_tr_b16 v[52:53], v117 offset:8192
  v_mfma_f32_16x16x32_bf16 v[204:207], v[76:79], v[32:35], v[204:207]
  ds_read_b64_tr_b16 v[54:55], v117 offset:9216
  v_mfma_f32_16x16x32_bf16 v[220:223], v[76:79], v[36:39], v[220:223]
  ds_read_b128 v[16:19], v116 offset:0
  v_mfma_f32_16x16x32_bf16 v[216:219], v[72:75], v[36:39], v[216:219]
  ds_read_b64_tr_b16 v[56:57], v118 offset:0
  v_mfma_f32_16x16x32_bf16 v[212:215], v[68:71], v[36:39], v[212:215]
  ds_read_b64_tr_b16 v[58:59], v118 offset:1024
  v_mfma_f32_16x16x32_bf16 v[208:211], v[64:67], v[36:39], v[208:211]
  ds_read_b64_tr_b16 v[60:61], v118 offset:8192
  v_mfma_f32_16x16x32_bf16 v[224:227], v[64:67], v[40:43], v[224:227]
  ds_read_b64_tr_b16 v[62:63], v118 offset:9216
  v_mfma_f32_16x16x32_bf16 v[228:231], v[68:71], v[40:43], v[228:231]
  ds_read_b128 v[20:23], v116 offset:1024
  v_mfma_f32_16x16x32_bf16 v[232:235], v[72:75], v[40:43], v[232:235]
  ds_read_b128 v[24:27], v116 offset:2048
  v_mfma_f32_16x16x32_bf16 v[236:239], v[76:79], v[40:43], v[236:239]
  ds_read_b128 v[28:31], v116 offset:3072
  v_mfma_f32_16x16x32_bf16 v[252:255], v[76:79], v[44:47], v[252:255]
  v_mfma_f32_16x16x32_bf16 v[248:251], v[72:75], v[44:47], v[248:251]
  v_mfma_f32_16x16x32_bf16 v[244:247], v[68:71], v[44:47], v[244:247]
  v_mfma_f32_16x16x32_bf16 v[240:243], v[64:67], v[44:47], v[240:243]
  s_waitcnt lgkmcnt(0)
  v_mfma_f32_16x16x32_bf16 v[128:131], v[48:51], v[16:19], v[128:131]
  ds_read_b128 v[32:35], v116 offset:4096
  v_mfma_f32_16x16x32_bf16 v[132:135], v[52:55], v[16:19], v[132:135]
  ds_read_b128 v[36:39], v116 offset:5120
  v_mfma_f32_16x16x32_bf16 v[136:139], v[56:59], v[16:19], v[136:139]
  ds_read_b128 v[40:43], v116 offset:6144
  v_mfma_f32_16x16x32_bf16 v[140:143], v[60:63], v[16:19], v[140:143]
  ds_read_b128 v[44:47], v116 offset:7168
  v_mfma_f32_16x16x32_bf16 v[156:159], v[60:63], v[20:23], v[156:159]
  s_add_u32 m0, s30, 49152
  v_mfma_f32_16x16x32_bf16 v[152:155], v[56:59], v[20:23], v[152:155]
  buffer_load_dwordx4 v4, s[12:15], s28 offen lds
  v_mfma_f32_16x16x32_bf16 v[148:151], v[52:55], v[20:23], v[148:151]
  s_add_u32 m0, s29, 32768
  v_mfma_f32_16x16x32_bf16 v[144:147], v[48:51], v[20:23], v[144:147]
  buffer_load_dwordx4 v3, s[8:11], s26 offen sc1 lds
  v_mfma_f32_16x16x32_bf16 v[160:163], v[48:51], v[24:27], v[160:163]
  v_mfma_f32_16x16x32_bf16 v[164:167], v[52:55], v[24:27], v[164:167]
  s_add_u32 m0, s30, 57344
  v_mfma_f32_16x16x32_bf16 v[168:171], v[56:59], v[24:27], v[168:171]
  buffer_load_dwordx4 v4, s[16:19], s28 offen lds
  s_add_u32 s28, s28, 229376
  v_mfma_f32_16x16x32_bf16 v[172:175], v[60:63], v[24:27], v[172:175]
  v_mfma_f32_16x16x32_bf16 v[188:191], v[60:63], v[28:31], v[188:191]
  s_add_u32 m0, s29, 33792
  v_mfma_f32_16x16x32_bf16 v[184:187], v[56:59], v[28:31], v[184:187]
  buffer_load_dwordx4 v112, s[8:11], s26 offen sc1 lds
  s_add_u32 s26, s26, 64
  v_mfma_f32_16x16x32_bf16 v[180:183], v[52:55], v[28:31], v[180:183]
  v_mfma_f32_16x16x32_bf16 v[176:179], v[48:51], v[28:31], v[176:179]
  s_waitcnt vmcnt(8) lgkmcnt(0)
  s_barrier
  v_mfma_f32_16x16x32_bf16 v[192:195], v[48:51], v[32:35], v[192:195]
  ds_read_b64_tr_b16 v[64:65], v117 offset:32768
  v_mfma_f32_16x16x32_bf16 v[196:199], v[52:55], v[32:35], v[196:199]
  ds_read_b64_tr_b16 v[66:67], v117 offset:33792
  v_mfma_f32_16x16x32_bf16 v[200:203], v[56:59], v[32:35], v[200:203]
  ds_read_b64_tr_b16 v[68:69], v117 offset:40960
  v_mfma_f32_16x16x32_bf16 v[204:207], v[60:63], v[32:35], v[204:207]
  ds_read_b64_tr_b16 v[70:71], v117 offset:41984
  v_mfma_f32_16x16x32_bf16 v[220:223], v[60:63], v[36:39], v[220:223]
  ds_read_b128 v[16:19], v116 offset:32768
  v_mfma_f32_16x16x32_bf16 v[216:219], v[56:59], v[36:39], v[216:219]
  ds_read_b64_tr_b16 v[72:73], v118 offset:32768
  v_mfma_f32_16x16x32_bf16 v[212:215], v[52:55], v[36:39], v[212:215]
  ds_read_b64_tr_b16 v[74:75], v118 offset:33792
  v_mfma_f32_16x16x32_bf16 v[208:211], v[48:51], v[36:39], v[208:211]
  ds_read_b64_tr_b16 v[76:77], v118 offset:40960
  v_mfma_f32_16x16x32_bf16 v[224:227], v[48:51], v[40:43], v[224:227]
  ds_read_b64_tr_b16 v[78:79], v118 offset:41984
  v_mfma_f32_16x16x32_bf16 v[228:231], v[52:55], v[40:43], v[228:231]
  ds_read_b128 v[20:23], v116 offset:33792
  v_mfma_f32_16x16x32_bf16 v[232:235], v[56:59], v[40:43], v[232:235]
  ds_read_b128 v[24:27], v116 offset:34816
  v_mfma_f32_16x16x32_bf16 v[236:239], v[60:63], v[40:43], v[236:239]
  ds_read_b128 v[28:31], v116 offset:35840
  v_mfma_f32_16x16x32_bf16 v[252:255], v[60:63], v[44:47], v[252:255]
  v_mfma_f32_16x16x32_bf16 v[248:251], v[56:59], v[44:47], v[248:251]
  v_mfma_f32_16x16x32_bf16 v[244:247], v[52:55], v[44:47], v[244:247]
  v_mfma_f32_16x16x32_bf16 v[240:243], v[48:51], v[44:47], v[240:243]
  s_waitcnt lgkmcnt(0)
  v_mfma_f32_16x16x32_bf16 v[128:131], v[64:67], v[16:19], v[128:131]
  ds_read_b128 v[32:35], v116 offset:36864
  v_mfma_f32_16x16x32_bf16 v[132:135], v[68:71], v[16:19], v[132:135]
  ds_read_b128 v[36:39], v116 offset:37888
  v_mfma_f32_16x16x32_bf16 v[136:139], v[72:75], v[16:19], v[136:139]
  ds_read_b128 v[40:43], v116 offset:38912
  v_mfma_f32_16x16x32_bf16 v[140:143], v[76:79], v[16:19], v[140:143]
  ds_read_b128 v[44:47], v116 offset:39936
  v_mfma_f32_16x16x32_bf16 v[156:159], v[76:79], v[20:23], v[156:159]
  s_add_u32 m0, s30, 81920
  v_mfma_f32_16x16x32_bf16 v[152:155], v[72:75], v[20:23], v[152:155]
  buffer_load_dwordx4 v4, s[12:15], s28 offen lds
  v_mfma_f32_16x16x32_bf16 v[148:151], v[68:71], v[20:23], v[148:151]
  s_add_u32 m0, s29, 65536
  v_mfma_f32_16x16x32_bf16 v[144:147], v[64:67], v[20:23], v[144:147]
  buffer_load_dwordx4 v3, s[8:11], s26 offen sc1 lds
  v_mfma_f32_16x16x32_bf16 v[160:163], v[64:67], v[24:27], v[160:163]
  v_mfma_f32_16x16x32_bf16 v[164:167], v[68:71], v[24:27], v[164:167]
  s_add_u32 m0, s30, 90112
  v_mfma_f32_16x16x32_bf16 v[168:171], v[72:75], v[24:27], v[168:171]
  buffer_load_dwordx4 v4, s[16:19], s28 offen lds
  s_add_u32 s28, s28, 229376
  v_mfma_f32_16x16x32_bf16 v[172:175], v[76:79], v[24:27], v[172:175]
  v_mfma_f32_16x16x32_bf16 v[188:191], v[76:79], v[28:31], v[188:191]
  s_add_u32 m0, s29, 66560
  v_mfma_f32_16x16x32_bf16 v[184:187], v[72:75], v[28:31], v[184:187]
  buffer_load_dwordx4 v112, s[8:11], s26 offen sc1 lds
  s_add_u32 s26, s26, 64
  v_mfma_f32_16x16x32_bf16 v[180:183], v[68:71], v[28:31], v[180:183]
  v_mfma_f32_16x16x32_bf16 v[176:179], v[64:67], v[28:31], v[176:179]
  s_waitcnt vmcnt(8) lgkmcnt(0)
  s_barrier
  v_mfma_f32_16x16x32_bf16 v[192:195], v[64:67], v[32:35], v[192:195]
  ds_read_b64_tr_b16 v[48:49], v7 offset:0
  v_mfma_f32_16x16x32_bf16 v[196:199], v[68:71], v[32:35], v[196:199]
  ds_read_b64_tr_b16 v[50:51], v7 offset:1024
  v_mfma_f32_16x16x32_bf16 v[200:203], v[72:75], v[32:35], v[200:203]
  ds_read_b64_tr_b16 v[52:53], v7 offset:8192
  v_mfma_f32_16x16x32_bf16 v[204:207], v[76:79], v[32:35], v[204:207]
  ds_read_b64_tr_b16 v[54:55], v7 offset:9216
  v_mfma_f32_16x16x32_bf16 v[220:223], v[76:79], v[36:39], v[220:223]
  ds_read_b128 v[16:19], v6 offset:0
  v_mfma_f32_16x16x32_bf16 v[216:219], v[72:75], v[36:39], v[216:219]
  ds_read_b64_tr_b16 v[56:57], v8 offset:0
  v_mfma_f32_16x16x32_bf16 v[212:215], v[68:71], v[36:39], v[212:215]
  ds_read_b64_tr_b16 v[58:59], v8 offset:1024
  v_mfma_f32_16x16x32_bf16 v[208:211], v[64:67], v[36:39], v[208:211]
  ds_read_b64_tr_b16 v[60:61], v8 offset:8192
  v_mfma_f32_16x16x32_bf16 v[224:227], v[64:67], v[40:43], v[224:227]
  ds_read_b64_tr_b16 v[62:63], v8 offset:9216
  v_mfma_f32_16x16x32_bf16 v[228:231], v[68:71], v[40:43], v[228:231]
  ds_read_b128 v[20:23], v6 offset:1024
  v_mfma_f32_16x16x32_bf16 v[232:235], v[72:75], v[40:43], v[232:235]
  ds_read_b128 v[24:27], v6 offset:2048
  v_mfma_f32_16x16x32_bf16 v[236:239], v[76:79], v[40:43], v[236:239]
  ds_read_b128 v[28:31], v6 offset:3072
  v_mfma_f32_16x16x32_bf16 v[252:255], v[76:79], v[44:47], v[252:255]
  v_mfma_f32_16x16x32_bf16 v[248:251], v[72:75], v[44:47], v[248:251]
  v_mfma_f32_16x16x32_bf16 v[244:247], v[68:71], v[44:47], v[244:247]
  v_mfma_f32_16x16x32_bf16 v[240:243], v[64:67], v[44:47], v[240:243]
  s_waitcnt lgkmcnt(0)
  v_mfma_f32_16x16x32_bf16 v[128:131], v[48:51], v[16:19], v[128:131]
  ds_read_b128 v[32:35], v6 offset:4096
  v_mfma_f32_16x16x32_bf16 v[132:135], v[52:55], v[16:19], v[132:135]
  ds_read_b128 v[36:39], v6 offset:5120
  v_mfma_f32_16x16x32_bf16 v[136:139], v[56:59], v[16:19], v[136:139]
  ds_read_b128 v[40:43], v6 offset:6144
  v_mfma_f32_16x16x32_bf16 v[140:143], v[60:63], v[16:19], v[140:143]
  ds_read_b128 v[44:47], v6 offset:7168
  v_mfma_f32_16x16x32_bf16 v[156:159], v[60:63], v[20:23], v[156:159]
  s_add_u32 m0, s30, 114688
  v_mfma_f32_16x16x32_bf16 v[152:155], v[56:59], v[20:23], v[152:155]
  buffer_load_dwordx4 v4, s[12:15], s28 offen lds
  v_mfma_f32_16x16x32_bf16 v[148:151], v[52:55], v[20:23], v[148:151]
  s_add_u32 m0, s29, 98304
  v_mfma_f32_16x16x32_bf16 v[144:147], v[48:51], v[20:23], v[144:147]
  buffer_load_dwordx4 v3, s[8:11], s26 offen sc1 lds
  v_mfma_f32_16x16x32_bf16 v[160:163], v[48:51], v[24:27], v[160:163]
  v_mfma_f32_16x16x32_bf16 v[164:167], v[52:55], v[24:27], v[164:167]
  s_add_u32 m0, s30, 122880
  v_mfma_f32_16x16x32_bf16 v[168:171], v[56:59], v[24:27], v[168:171]
  buffer_load_dwordx4 v4, s[16:19], s28 offen lds
  s_add_u32 s28, s28, 229376
  v_mfma_f32_16x16x32_bf16 v[172:175], v[60:63], v[24:27], v[172:175]
  v_mfma_f32_16x16x32_bf16 v[188:191], v[60:63], v[28:31], v[188:191]
  s_add_u32 m0, s29, 99328
  v_mfma_f32_16x16x32_bf16 v[184:187], v[56:59], v[28:31], v[184:187]
  buffer_load_dwordx4 v112, s[8:11], s26 offen sc1 lds
  s_add_u32 s26, s26, 64
  v_mfma_f32_16x16x32_bf16 v[180:183], v[52:55], v[28:31], v[180:183]
  v_mfma_f32_16x16x32_bf16 v[176:179], v[48:51], v[28:31], v[176:179]
  s_waitcnt vmcnt(8) lgkmcnt(0)
  s_barrier
  v_mfma_f32_16x16x32_bf16 v[192:195], v[48:51], v[32:35], v[192:195]
  ds_read_b64_tr_b16 v[64:65], v7 offset:32768
  v_mfma_f32_16x16x32_bf16 v[196:199], v[52:55], v[32:35], v[196:199]
  ds_read_b64_tr_b16 v[66:67], v7 offset:33792
  v_mfma_f32_16x16x32_bf16 v[200:203], v[56:59], v[32:35], v[200:203]
  ds_read_b64_tr_b16 v[68:69], v7 offset:40960
  v_mfma_f32_16x16x32_bf16 v[204:207], v[60:63], v[32:35], v[204:207]
  ds_read_b64_tr_b16 v[70:71], v7 offset:41984
  v_mfma_f32_16x16x32_bf16 v[220:223], v[60:63], v[36:39], v[220:223]
  ds_read_b128 v[16:19], v6 offset:32768
  v_mfma_f32_16x16x32_bf16 v[216:219], v[56:59], v[36:39], v[216:219]
  ds_read_b64_tr_b16 v[72:73], v8 offset:32768
  v_mfma_f32_16x16x32_bf16 v[212:215], v[52:55], v[36:39], v[212:215]
  ds_read_b64_tr_b16 v[74:75], v8 offset:33792
  v_mfma_f32_16x16x32_bf16 v[208:211], v[48:51], v[36:39], v[208:211]
  ds_read_b64_tr_b16 v[76:77], v8 offset:40960
  v_mfma_f32_16x16x32_bf16 v[224:227], v[48:51], v[40:43], v[224:227]
  ds_read_b64_tr_b16 v[78:79], v8 offset:41984
  v_mfma_f32_16x16x32_bf16 v[228:231], v[52:55], v[40:43], v[228:231]
  ds_read_b128 v[20:23], v6 offset:33792
  v_mfma_f32_16x16x32_bf16 v[232:235], v[56:59], v[40:43], v[232:235]
  ds_read_b128 v[24:27], v6 offset:34816
  v_mfma_f32_16x16x32_bf16 v[236:239], v[60:63], v[40:43], v[236:239]
  ds_read_b128 v[28:31], v6 offset:35840
  v_mfma_f32_16x16x32_bf16 v[252:255], v[60:63], v[44:47], v[252:255]
  v_mfma_f32_16x16x32_bf16 v[248:251], v[56:59], v[44:47], v[248:251]
  v_mfma_f32_16x16x32_bf16 v[244:247], v[52:55], v[44:47], v[244:247]
  v_mfma_f32_16x16x32_bf16 v[240:243], v[48:51], v[44:47], v[240:243]
  s_sub_u32 s31, s31, 1
  s_cmp_lg_u32 s31, 0
  s_cbranch_scc1 g1_loop
  s_waitcnt lgkmcnt(0)
  v_mfma_f32_16x16x32_bf16 v[128:131], v[64:67], v[16:19], v[128:131]
  ds_read_b128 v[32:35], v6 offset:36864
  v_mfma_f32_16x16x32_bf16 v[132:135], v[68:71], v[16:19], v[132:135]
  ds_read_b128 v[36:39], v6 offset:37888
  v_mfma_f32_16x16x32_bf16 v[136:139], v[72:75], v[16:19], v[136:139]
  ds_read_b128 v[40:43], v6 offset:38912
  v_mfma_f32_16x16x32_bf16 v[140:143], v[76:79], v[16:19], v[140:143]
  ds_read_b128 v[44:47], v6 offset:39936
  v_mfma_f32_16x16x32_bf16 v[156:159], v[76:79], v[20:23], v[156:159]
  v_mfma_f32_16x16x32_bf16 v[152:155], v[72:75], v[20:23], v[152:155]
  v_mfma_f32_16x16x32_bf16 v[148:151], v[68:71], v[20:23], v[148:151]
  v_mfma_f32_16x16x32_bf16 v[144:147], v[64:67], v[20:23], v[144:147]
  v_mfma_f32_16x16x32_bf16 v[160:163], v[64:67], v[24:27], v[160:163]
  v_mfma_f32_16x16x32_bf16 v[164:167], v[68:71], v[24:27], v[164:167]
  v_mfma_f32_16x16x32_bf16 v[168:171], v[72:75], v[24:27], v[168:171]
  v_mfma_f32_16x16x32_bf16 v[172:175], v[76:79], v[24:27], v[172:175]
  v_mfma_f32_16x16x32_bf16 v[188:191], v[76:79], v[28:31], v[188:191]
  v_mfma_f32_16x16x32_bf16 v[184:187], v[72:75], v[28:31], v[184:187]
  v_mfma_f32_16x16x32_bf16 v[180:183], v[68:71], v[28:31], v[180:183]
  v_mfma_f32_16x16x32_bf16 v[176:179], v[64:67], v[28:31], v[176:179]
  s_waitcnt vmcnt(4) lgkmcnt(0)
  s_barrier
  v_mfma_f32_16x16x32_bf16 v[192:195], v[64:67], v[32:35], v[192:195]
  ds_read_b64_tr_b16 v[48:49], v117 offset:0
  v_mfma_f32_16x16x32_bf16 v[196:199], v[68:71], v[32:35], v[196:199]
  ds_read_b64_tr_b16 v[50:51], v117 offset:1024
  v_mfma_f32_16x16x32_bf16 v[200:203], v[72:75], v[32:35], v[200:203]
  ds_read_b64_tr_b16 v[52:53], v117 offset:8192
  v_mfma_f32_16x16x32_bf16 v[204:207], v[76:79], v[32:35], v[204:207]
  ds_read_b64_tr_b16 v[54:55], v117 offset:9216
  v_mfma_f32_16x16x32_bf16 v[220:223], v[76:79], v[36:39], v[220:223]
  ds_read_b128 v[16:19], v116 offset:0
  v_mfma_f32_16x16x32_bf16 v[216:219], v[72:75], v[36:39], v[216:219]
  ds_read_b64_tr_b16 v[56:57], v118 offset:0
  v_mfma_f32_16x16x32_bf16 v[212:215], v[68:71], v[36:39], v[212:215]
  ds_read_b64_tr_b16 v[58:59], v118 offset:1024
  v_mfma_f32_16x16x32_bf16 v[208:211], v[64:67], v[36:39], v[208:211]
  ds_read_b64_tr_b16 v[60:61], v118 offset:8192
  v_mfma_f32_16x16x32_bf16 v[224:227], v[64:67], v[40:43], v[224:227]
  ds_read_b64_tr_b16 v[62:63], v118 offset:9216
  v_mfma_f32_16x16x32_bf16 v[228:231], v[68:71], v[40:43], v[228:231]
  ds_read_b128 v[20:23], v116 offset:1024
  v_mfma_f32_16x16x32_bf16 v[232:235], v[72:75], v[40:43], v[232:235]
  ds_read_b128 v[24:27], v116 offset:2048
  v_mfma_f32_16x16x32_bf16 v[236:239], v[76:79], v[40:43], v[236:239]
  ds_read_b128 v[28:31], v116 offset:3072
  v_mfma_f32_16x16x32_bf16 v[252:255], v[76:79], v[44:47], v[252:255]
  v_mfma_f32_16x16x32_bf16 v[248:251], v[72:75], v[44:47], v[248:251]
  v_mfma_f32_16x16x32_bf16 v[244:247], v[68:71], v[44:47], v[244:247]
  v_mfma_f32_16x16x32_bf16 v[240:243], v[64:67], v[44:47], v[240:243]
  s_waitcnt lgkmcnt(0)
  v_mfma_f32_16x16x32_bf16 v[128:131], v[48:51], v[16:19], v[128:131]
  ds_read_b128 v[32:35], v116 offset:4096
  v_mfma_f32_16x16x32_bf16 v[132:135], v[52:55], v[16:19], v[132:135]
  ds_read_b128 v[36:39], v116 offset:5120
  v_mfma_f32_16x16x32_bf16 v[136:139], v[56:59], v[16:19], v[136:139]
  ds_read_b128 v[40:43], v116 offset:6144
  v_mfma_f32_16x16x32_bf16 v[140:143], v[60:63], v[16:19], v[140:143]
  ds_read_b128 v[44:47], v116 offset:7168
  v_mfma_f32_16x16x32_bf16 v[156:159], v[60:63], v[20:23], v[156:159]
  v_mfma_f32_16x16x32_bf16 v[152:155], v[56:59], v[20:23], v[152:155]
  v_mfma_f32_16x16x32_bf16 v[148:151], v[52:55], v[20:23], v[148:151]
  v_mfma_f32_16x16x32_bf16 v[144:147], v[48:51], v[20:23], v[144:147]
  v_mfma_f32_16x16x32_bf16 v[160:163], v[48:51], v[24:27], v[160:163]
  v_mfma_f32_16x16x32_bf16 v[164:167], v[52:55], v[24:27], v[164:167]
  v_mfma_f32_16x16x32_bf16 v[168:171], v[56:59], v[24:27], v[168:171]
  v_mfma_f32_16x16x32_bf16 v[172:175], v[60:63], v[24:27], v[172:175]
  v_mfma_f32_16x16x32_bf16 v[188:191], v[60:63], v[28:31], v[188:191]
  v_mfma_f32_16x16x32_bf16 v[184:187], v[56:59], v[28:31], v[184:187]
  v_mfma_f32_16x16x32_bf16 v[180:183], v[52:55], v[28:31], v[180:183]
  v_mfma_f32_16x16x32_bf16 v[176:179], v[48:51], v[28:31], v[176:179]
  s_waitcnt vmcnt(0) lgkmcnt(0)
  s_barrier
  v_mfma_f32_16x16x32_bf16 v[192:195], v[48:51], v[32:35], v[192:195]
  ds_read_b64_tr_b16 v[64:65], v117 offset:32768
  v_mfma_f32_16x16x32_bf16 v[196:199], v[52:55], v[32:35], v[196:199]
  ds_read_b64_tr_b16 v[66:67], v117 offset:33792
  v_mfma_f32_16x16x32_bf16 v[200:203], v[56:59], v[32:35], v[200:203]
  ds_read_b64_tr_b16 v[68:69], v117 offset:40960
  v_mfma_f32_16x16x32_bf16 v[204:207], v[60:63], v[32:35], v[204:207]
  ds_read_b64_tr_b16 v[70:71], v117 offset:41984
  v_mfma_f32_16x16x32_bf16 v[220:223], v[60:63], v[36:39], v[220:223]
  ds_read_b128 v[16:19], v116 offset:32768
  v_mfma_f32_16x16x32_bf16 v[216:219], v[56:59], v[36:39], v[216:219]
  ds_read_b64_tr_b16 v[72:73], v118 offset:32768
  v_mfma_f32_16x16x32_bf16 v[212:215], v[52:55], v[36:39], v[212:215]
  ds_read_b64_tr_b16 v[74:75], v118 offset:33792
  v_mfma_f32_16x16x32_bf16 v[208:211], v[48:51], v[36:39], v[208:211]
  ds_read_b64_tr_b16 v[76:77], v118 offset:40960
  v_mfma_f32_16x16x32_bf16 v[224:227], v[48:51], v[40:43], v[224:227]
  ds_read_b64_tr_b16 v[78:79], v118 offset:41984
  v_mfma_f32_16x16x32_bf16 v[228:231], v[52:55], v[40:43], v[228:231]
  ds_read_b128 v[20:23], v116 offset:33792
  v_mfma_f32_16x16x32_bf16 v[232:235], v[56:59], v[40:43], v[232:235]
  ds_read_b128 v[24:27], v116 offset:34816
  v_mfma_f32_16x16x32_bf16 v[236:239], v[60:63], v[40:43], v[236:239]
  ds_read_b128 v[28:31], v116 offset:35840
  v_mfma_f32_16x16x32_bf16 v[252:255], v[60:63], v[44:47], v[252:255]
  v_mfma_f32_16x16x32_bf16 v[248:251], v[56:59], v[44:47], v[248:251]
  v_mfma_f32_16x16x32_bf16 v[244:247], v[52:55], v[44:47], v[244:247]
  v_mfma_f32_16x16x32_bf16 v[240:243], v[48:51], v[44:47], v[240:243]
  s_lshl_b32 s87, s21, 10
  s_add_u32 s87, s87, s22
  s_lshl_b32 s87, s87, 2
  s_add_u32 s87, s87, 0x1000
  s_mov_b32 s86, -1
  s_lshl_b32 s21, s21, 4
  s_lshr_b32 s23, s20, 2
  s_lshl_b32 s23, s23, 3
  s_add_u32 s21, s21, s23
  s_mul_i32 s21, s21, 112
  s_lshl_b32 s22, s22, 2
  s_and_b32 s23, s20, 3
  s_lshl_b32 s23, s23, 0
  s_add_u32 s21, s21, s22
  s_add_u32 s21, s21, s23
  s_lshl_b32 s21, s21, 10
  v_lshlrev_b32 v3, 4, v2
  s_waitcnt lgkmcnt(0)
  v_mfma_f32_16x16x32_bf16 v[128:131], v[64:67], v[16:19], v[128:131]
  ds_read_b128 v[32:35], v116 offset:36864
  v_mfma_f32_16x16x32_bf16 v[132:135], v[68:71], v[16:19], v[132:135]
  ds_read_b128 v[36:39], v116 offset:37888
  v_mfma_f32_16x16x32_bf16 v[136:139], v[72:75], v[16:19], v[136:139]
  ds_read_b128 v[40:43], v116 offset:38912
  v_mfma_f32_16x16x32_bf16 v[140:143], v[76:79], v[16:19], v[140:143]
  ds_read_b128 v[44:47], v116 offset:39936
  v_mfma_f32_16x16x32_bf16 v[156:159], v[76:79], v[20:23], v[156:159]
  v_mfma_f32_16x16x32_bf16 v[152:155], v[72:75], v[20:23], v[152:155]
  v_mfma_f32_16x16x32_bf16 v[148:151], v[68:71], v[20:23], v[148:151]
  v_mfma_f32_16x16x32_bf16 v[144:147], v[64:67], v[20:23], v[144:147]
  v_mfma_f32_16x16x32_bf16 v[160:163], v[64:67], v[24:27], v[160:163]
  v_mfma_f32_16x16x32_bf16 v[164:167], v[68:71], v[24:27], v[164:167]
  v_mfma_f32_16x16x32_bf16 v[168:171], v[72:75], v[24:27], v[168:171]
  v_mfma_f32_16x16x32_bf16 v[172:175], v[76:79], v[24:27], v[172:175]
  v_mfma_f32_16x16x32_bf16 v[188:191], v[76:79], v[28:31], v[188:191]
  v_mfma_f32_16x16x32_bf16 v[184:187], v[72:75], v[28:31], v[184:187]
  v_mfma_f32_16x16x32_bf16 v[180:183], v[68:71], v[28:31], v[180:183]
  v_mfma_f32_16x16x32_bf16 v[176:179], v[64:67], v[28:31], v[176:179]
  s_waitcnt lgkmcnt(0)
  v_mfma_f32_16x16x32_bf16 v[192:195], v[64:67], v[32:35], v[192:195]
  v_pk_mul_f32 v[128:129], v[128:129], v[132:133]
  v_pk_mul_f32 v[130:131], v[130:131], v[134:135]
  v_pk_mul_f32 v[136:137], v[136:137], v[140:141]
  v_mfma_f32_16x16x32_bf16 v[196:199], v[68:71], v[32:35], v[196:199]
  v_pk_mul_f32 v[138:139], v[138:139], v[142:143]
  v_cvt_pk_bf16_f32 v16, v128, v129
  v_cvt_pk_bf16_f32 v17, v130, v131
  v_mfma_f32_16x16x32_bf16 v[200:203], v[72:75], v[32:35], v[200:203]
  v_cvt_pk_bf16_f32 v18, v136, v137
  v_cvt_pk_bf16_f32 v19, v138, v139
  buffer_store_dwordx4 v[16:19], v3, s[32:35], s21 offen sc1
  v_mfma_f32_16x16x32_bf16 v[204:207], v[76:79], v[32:35], v[204:207]
  s_add_u32 s21, s21, 114688
  v_pk_mul_f32 v[144:145], v[144:145], v[148:149]
  v_pk_mul_f32 v[146:147], v[146:147], v[150:151]
  v_mfma_f32_16x16x32_bf16 v[220:223], v[76:79], v[36:39], v[220:223]
  v_pk_mul_f32 v[152:153], v[152:153], v[156:157]
  v_pk_mul_f32 v[154:155], v[154:155], v[158:159]
  v_cvt_pk_bf16_f32 v20, v144, v145
  v_mfma_f32_16x16x32_bf16 v[216:219], v[72:75], v[36:39], v[216:219]
  v_cvt_pk_bf16_f32 v21, v146, v147
  v_cvt_pk_bf16_f32 v22, v152, v153
  v_cvt_pk_bf16_f32 v23, v154, v155
  v_mfma_f32_16x16x32_bf16 v[212:215], v[68:71], v[36:39], v[212:215]
  buffer_store_dwordx4 v[20:23], v3, s[32:35], s21 offen sc1
  s_add_u32 s21, s21, 114688
  v_pk_mul_f32 v[160:161], v[160:161], v[164:165]
  v_mfma_f32_16x16x32_bf16 v[208:211], v[64:67], v[36:39], v[208:211]
  v_pk_mul_f32 v[162:163], v[162:163], v[166:167]
  v_pk_mul_f32 v[168:169], v[168:169], v[172:173]
  v_pk_mul_f32 v[170:171], v[170:171], v[174:175]
  v_mfma_f32_16x16x32_bf16 v[224:227], v[64:67], v[40:43], v[224:227]
  v_cvt_pk_bf16_f32 v24, v160, v161
  v_cvt_pk_bf16_f32 v25, v162, v163
  v_cvt_pk_bf16_f32 v26, v168, v169
  v_mfma_f32_16x16x32_bf16 v[228:231], v[68:71], v[40:43], v[228:231]
  v_cvt_pk_bf16_f32 v27, v170, v171
  buffer_store_dwordx4 v[24:27], v3, s[32:35], s21 offen sc1
  s_add_u32 s21, s21, 114688
  v_mfma_f32_16x16x32_bf16 v[232:235], v[72:75], v[40:43], v[232:235]
  v_pk_mul_f32 v[176:177], v[176:177], v[180:181]
  v_pk_mul_f32 v[178:179], v[178:179], v[182:183]
  v_pk_mul_f32 v[184:185], v[184:185], v[188:189]
  v_mfma_f32_16x16x32_bf16 v[236:239], v[76:79], v[40:43], v[236:239]
  v_pk_mul_f32 v[186:187], v[186:187], v[190:191]
  v_cvt_pk_bf16_f32 v28, v176, v177
  v_cvt_pk_bf16_f32 v29, v178, v179
  v_mfma_f32_16x16x32_bf16 v[252:255], v[76:79], v[44:47], v[252:255]
  v_cvt_pk_bf16_f32 v30, v184, v185
  v_cvt_pk_bf16_f32 v31, v186, v187
  buffer_store_dwordx4 v[28:31], v3, s[32:35], s21 offen sc1
  v_mfma_f32_16x16x32_bf16 v[248:251], v[72:75], v[44:47], v[248:251]
  s_add_u32 s21, s21, 114688
  v_mfma_f32_16x16x32_bf16 v[244:247], v[68:71], v[44:47], v[244:247]
  v_mfma_f32_16x16x32_bf16 v[240:243], v[64:67], v[44:47], v[240:243]
  v_pk_mul_f32 v[192:193], v[192:193], v[196:197]
  v_pk_mul_f32 v[194:195], v[194:195], v[198:199]
  v_pk_mul_f32 v[200:201], v[200:201], v[204:205]
  v_pk_mul_f32 v[202:203], v[202:203], v[206:207]
  v_cvt_pk_bf16_f32 v32, v192, v193
  v_cvt_pk_bf16_f32 v33, v194, v195
  v_cvt_pk_bf16_f32 v34, v200, v201
  v_cvt_pk_bf16_f32 v35, v202, v203
  buffer_store_dwordx4 v[32:35], v3, s[32:35], s21 offen sc1
  s_add_u32 s21, s21, 114688
  v_pk_mul_f32 v[208:209], v[208:209], v[212:213]
  v_pk_mul_f32 v[210:211], v[210:211], v[214:215]
  v_pk_mul_f32 v[216:217], v[216:217], v[220:221]
  v_pk_mul_f32 v[218:219], v[218:219], v[222:223]
  v_cvt_pk_bf16_f32 v36, v208, v209
  v_cvt_pk_bf16_f32 v37, v210, v211
  v_cvt_pk_bf16_f32 v38, v216, v217
  v_cvt_pk_bf16_f32 v39, v218, v219
  buffer_store_dwordx4 v[36:39], v3, s[32:35], s21 offen sc1
  s_add_u32 s21, s21, 114688
  v_pk_mul_f32 v[224:225], v[224:225], v[228:229]
  v_pk_mul_f32 v[226:227], v[226:227], v[230:231]
  v_pk_mul_f32 v[232:233], v[232:233], v[236:237]
  v_pk_mul_f32 v[234:235], v[234:235], v[238:239]
  v_cvt_pk_bf16_f32 v40, v224, v225
  v_cvt_pk_bf16_f32 v41, v226, v227
  v_cvt_pk_bf16_f32 v42, v232, v233
  v_cvt_pk_bf16_f32 v43, v234, v235
  buffer_store_dwordx4 v[40:43], v3, s[32:35], s21 offen sc1
  s_add_u32 s21, s21, 114688
  v_pk_mul_f32 v[240:241], v[240:241], v[244:245]
  v_pk_mul_f32 v[242:243], v[242:243], v[246:247]
  v_pk_mul_f32 v[248:249], v[248:249], v[252:253]
  v_pk_mul_f32 v[250:251], v[250:251], v[254:255]
  v_cvt_pk_bf16_f32 v44, v240, v241
  v_cvt_pk_bf16_f32 v45, v242, v243
  v_cvt_pk_bf16_f32 v46, v248, v249
  v_cvt_pk_bf16_f32 v47, v250, v251
  buffer_store_dwordx4 v[44:47], v3, s[32:35], s21 offen sc1
  s_add_u32 s21, s21, 114688
  s_branch k2_in
k1_fft:
  s_lshl_b32 s87, s2, 2
  s_add_u32 s87, s87, 73728
  s_waitcnt vmcnt(0)
  s_barrier
  s_cmp_lg_u32 s20, 1
  s_cbranch_scc1 cf_sx
  v_mov_b32 v14, s88
  v_lshlrev_b32 v15, 10, v2
  s_mov_b32 exec_lo, 255
  s_mov_b32 exec_hi, 0
  buffer_store_dword v14, v15, s[92:95], s87 offen sc1
  s_mov_b64 exec, -1
cf_sx:
  s_lshl_b32 s21, s3, 2
  s_lshr_b32 s4, s2, 3
  s_add_u32 s21, s21, s4
  s_sub_u32 s21, s21, 28
  v_and_b32 v12, 31, v2
  v_lshrrev_b32 v13, 5, v2
  v_lshrrev_b32 v4, 4, v2
  v_lshl_add_u32 v14, v1, 5, v4
  v_lshlrev_b32 v14, 14, v14
  v_xor_b32 v4, v4, v2
  v_and_b32 v3, 7, v4
  v_lshl_add_u32 v3, v3, 4, v14
  v_bfe_u32 v15, v4, 3, 1
  v_lshl_add_u32 v3, v15, 13, v3
  v_and_b32 v4, 15, v4
  v_lshl_add_u32 v4, v4, 4, v14
  s_lshl_b32 s22, s21, 8
  s_lshl_b32 s23, s21, 9
  s_lshl_b32 s29, s20, 13
  s_lshl_b32 s44, s21, 17
  s_mov_b32 s31, 0
  s_cmp_eq_u32 s21, 0
  s_cselect_b32 s30, 3, 2
  s_add_u32 s8, s90, 0x400000
  s_addc_u32 s9, s91, 0
  s_mov_b32 s10, 0x400000
  s_mov_b32 s11, 0x20000
  s_add_u32 s12, s90, 0x2400000
  s_addc_u32 s13, s91, 0
  s_mov_b32 s14, 0x800000
  s_mov_b32 s15, 0x20000
  s_add_u32 s32, s90, 0x1800000
  s_addc_u32 s33, s91, 0
  s_mov_b32 s34, 0x400000
  s_mov_b32 s35, 0x20000
  s_add_u32 s40, s90, 0x2000000
  s_addc_u32 s41, s91, 0
  s_mov_b32 s42, 0x2000
  s_mov_b32 s43, 0x20000
  s_load_dwordx4 s[4:7], s[0:1], 32
  s_load_dwordx2 s[46:47], s[0:1], 48
  s_lshl_b32 s24, s21, 15
  s_cselect_b32 s24, s24, 0x40000000
  s_add_u32 s24, s24, 0xd8000
  v_and_b32 v255, 255, v0
  v_lshlrev_b32 v255, 7, v255
  v_add_u32 v255, s24, v255
  s_mov_b32 s45, 0xf8000
  s_waitcnt lgkmcnt(0)
  s_cmp_lt_u32 s20, 4
  s_cselect_b64 s[4:5], s[4:5], s[6:7]
  s_mov_b32 s36, s4
  s_mov_b32 s37, s5
  s_mov_b32 s38, 0x700000
  s_mov_b32 s39, 0x20000
  buffer_load_dword v254, v255, s[36:39], 0 offen
  v_add_u32 v255, s45, v255
  buffer_load_dword v254, v255, s[36:39], 0 offen
  v_add_u32 v255, s45, v255
  v_cvt_f32_u32 v6, v12
  v_cvt_f32_u32 v7, v13
  v_mul_f32 v7, 4.0, v7
  v_mul_f32 v8, 0xbd000000, v6
  v_mul_f32 v9, v7, v8
  v_mov_b32 v88, -2.0
  v_mov_b32 v89, -2.0
  v_fmamk_f32 v96, v8, 0x0, v9
  v_fmamk_f32 v97, v8, 0x3f800000, v9
  v_cos_f32 v98, v96
  v_cos_f32 v99, v97
  v_sin_f32 v96, v96
  v_sin_f32 v97, v97
  v_cvt_pk_bf16_f32 v16, v98, v99
  v_cvt_pk_bf16_f32 v24, v96, v97
  v_fmamk_f32 v96, v8, 0x40000000, v9
  v_fmamk_f32 v97, v8, 0x40400000, v9
  v_cos_f32 v98, v96
  v_cos_f32 v99, v97
  v_sin_f32 v96, v96
  v_sin_f32 v97, v97
  v_cvt_pk_bf16_f32 v17, v98, v99
  v_cvt_pk_bf16_f32 v25, v96, v97
  v_fmamk_f32 v96, v8, 0x41000000, v9
  v_fmamk_f32 v97, v8, 0x41100000, v9
  v_cos_f32 v98, v96
  v_cos_f32 v99, v97
  v_sin_f32 v96, v96
  v_sin_f32 v97, v97
  v_cvt_pk_bf16_f32 v18, v98, v99
  v_cvt_pk_bf16_f32 v26, v96, v97
  v_fmamk_f32 v96, v8, 0x41200000, v9
  v_fmamk_f32 v97, v8, 0x41300000, v9
  v_cos_f32 v98, v96
  v_cos_f32 v99, v97
  v_sin_f32 v96, v96
  v_sin_f32 v97, v97
  v_cvt_pk_bf16_f32 v19, v98, v99
  v_cvt_pk_bf16_f32 v27, v96, v97
  v_fmamk_f32 v96, v8, 0x41800000, v9
  v_fmamk_f32 v97, v8, 0x41880000, v9
  v_cos_f32 v98, v96
  v_cos_f32 v99, v97
  v_sin_f32 v96, v96
  v_sin_f32 v97, v97
  v_cvt_pk_bf16_f32 v20, v98, v99
  v_cvt_pk_bf16_f32 v28, v96, v97
  v_fmamk_f32 v96, v8, 0x41900000, v9
  v_fmamk_f32 v97, v8, 0x41980000, v9
  v_cos_f32 v98, v96
  v_cos_f32 v99, v97
  v_sin_f32 v96, v96
  v_sin_f32 v97, v97
  v_cvt_pk_bf16_f32 v21, v98, v99
  v_cvt_pk_bf16_f32 v29, v96, v97
  v_fmamk_f32 v96, v8, 0x41c00000, v9
  v_fmamk_f32 v97, v8, 0x41c80000, v9
  v_cos_f32 v98, v96
  v_cos_f32 v99, v97
  v_sin_f32 v96, v96
  v_sin_f32 v97, v97
  v_cvt_pk_bf16_f32 v22, v98, v99
  v_cvt_pk_bf16_f32 v30, v96, v97
  v_fmamk_f32 v96, v8, 0x41d00000, v9
  v_fmamk_f32 v97, v8, 0x41d80000, v9
  v_cos_f32 v98, v96
  v_cos_f32 v99, v97
  v_sin_f32 v96, v96
  v_sin_f32 v97, v97
  v_cvt_pk_bf16_f32 v23, v98, v99
  v_cvt_pk_bf16_f32 v31, v96, v97
  v_mul_f32 v8, 0xbc800000, v6
  v_mul_f32 v9, v7, v8
  v_fmamk_f32 v96, v8, 0x0, v9
  v_fmamk_f32 v97, v8, 0x40000000, v9
  v_cos_f32 v98, v96
  v_cos_f32 v99, v97
  v_sin_f32 v96, v96
  v_sin_f32 v97, v97
  v_cvt_pk_bf16_f32 v40, v98, v99
  v_cvt_pk_bf16_f32 v56, v96, v97
  v_fmamk_f32 v96, v8, 0x41000000, v9
  v_fmamk_f32 v97, v8, 0x41200000, v9
  v_cos_f32 v98, v96
  v_cos_f32 v99, v97
  v_sin_f32 v96, v96
  v_sin_f32 v97, v97
  v_cvt_pk_bf16_f32 v41, v98, v99
  v_cvt_pk_bf16_f32 v57, v96, v97
  v_fmamk_f32 v96, v8, 0x41800000, v9
  v_fmamk_f32 v97, v8, 0x41900000, v9
  v_cos_f32 v98, v96
  v_cos_f32 v99, v97
  v_sin_f32 v96, v96
  v_sin_f32 v97, v97
  v_cvt_pk_bf16_f32 v42, v98, v99
  v_cvt_pk_bf16_f32 v58, v96, v97
  v_fmamk_f32 v96, v8, 0x41c00000, v9
  v_fmamk_f32 v97, v8, 0x41d00000, v9
  v_cos_f32 v98, v96
  v_cos_f32 v99, v97
  v_sin_f32 v96, v96
  v_sin_f32 v97, v97
  v_cvt_pk_bf16_f32 v43, v98, v99
  v_cvt_pk_bf16_f32 v59, v96, v97
  v_fmamk_f32 v96, v8, 0x42000000, v9
  v_fmamk_f32 v97, v8, 0x42080000, v9
  v_cos_f32 v98, v96
  v_cos_f32 v99, v97
  v_sin_f32 v96, v96
  v_sin_f32 v97, v97
  v_cvt_pk_bf16_f32 v44, v98, v99
  v_cvt_pk_bf16_f32 v60, v96, v97
  v_fmamk_f32 v96, v8, 0x42200000, v9
  v_fmamk_f32 v97, v8, 0x42280000, v9
  v_cos_f32 v98, v96
  v_cos_f32 v99, v97
  v_sin_f32 v96, v96
  v_sin_f32 v97, v97
  v_cvt_pk_bf16_f32 v45, v98, v99
  v_cvt_pk_bf16_f32 v61, v96, v97
  v_fmamk_f32 v96, v8, 0x42400000, v9
  v_fmamk_f32 v97, v8, 0x42480000, v9
  v_cos_f32 v98, v96
  v_cos_f32 v99, v97
  v_sin_f32 v96, v96
  v_sin_f32 v97, v97
  v_cvt_pk_bf16_f32 v46, v98, v99
  v_cvt_pk_bf16_f32 v62, v96, v97
  v_fmamk_f32 v96, v8, 0x42600000, v9
  v_fmamk_f32 v97, v8, 0x42680000, v9
  v_cos_f32 v98, v96
  v_cos_f32 v99, v97
  v_sin_f32 v96, v96
  v_sin_f32 v97, v97
  v_cvt_pk_bf16_f32 v47, v98, v99
  v_cvt_pk_bf16_f32 v63, v96, v97
  v_fmamk_f32 v96, v8, 0x3f800000, v9
  v_fmamk_f32 v97, v8, 0x40400000, v9
  v_cos_f32 v98, v96
  v_cos_f32 v99, v97
  v_sin_f32 v96, v96
  v_sin_f32 v97, v97
  v_cvt_pk_bf16_f32 v48, v98, v99
  v_cvt_pk_bf16_f32 v64, v96, v97
  v_fmamk_f32 v96, v8, 0x41100000, v9
  v_fmamk_f32 v97, v8, 0x41300000, v9
  v_cos_f32 v98, v96
  v_cos_f32 v99, v97
  v_sin_f32 v96, v96
  v_sin_f32 v97, v97
  v_cvt_pk_bf16_f32 v49, v98, v99
  v_cvt_pk_bf16_f32 v65, v96, v97
  v_fmamk_f32 v96, v8, 0x41880000, v9
  v_fmamk_f32 v97, v8, 0x41980000, v9
  v_cos_f32 v98, v96
  v_cos_f32 v99, v97
  v_sin_f32 v96, v96
  v_sin_f32 v97, v97
  v_cvt_pk_bf16_f32 v50, v98, v99
  v_cvt_pk_bf16_f32 v66, v96, v97
  v_fmamk_f32 v96, v8, 0x41c80000, v9
  v_fmamk_f32 v97, v8, 0x41d80000, v9
  v_cos_f32 v98, v96
  v_cos_f32 v99, v97
  v_sin_f32 v96, v96
  v_sin_f32 v97, v97
  v_cvt_pk_bf16_f32 v51, v98, v99
  v_cvt_pk_bf16_f32 v67, v96, v97
  v_fmamk_f32 v96, v8, 0x42040000, v9
  v_fmamk_f32 v97, v8, 0x420c0000, v9
  v_cos_f32 v98, v96
  v_cos_f32 v99, v97
  v_sin_f32 v96, v96
  v_sin_f32 v97, v97
  v_cvt_pk_bf16_f32 v52, v98, v99
  v_cvt_pk_bf16_f32 v68, v96, v97
  v_fmamk_f32 v96, v8, 0x42240000, v9
  v_fmamk_f32 v97, v8, 0x422c0000, v9
  v_cos_f32 v98, v96
  v_cos_f32 v99, v97
  v_sin_f32 v96, v96
  v_sin_f32 v97, v97
  v_cvt_pk_bf16_f32 v53, v98, v99
  v_cvt_pk_bf16_f32 v69, v96, v97
  v_fmamk_f32 v96, v8, 0x42440000, v9
  v_fmamk_f32 v97, v8, 0x424c0000, v9
  v_cos_f32 v98, v96
  v_cos_f32 v99, v97
  v_sin_f32 v96, v96
  v_sin_f32 v97, v97
  v_cvt_pk_bf16_f32 v54, v98, v99
  v_cvt_pk_bf16_f32 v70, v96, v97
  v_fmamk_f32 v96, v8, 0x42640000, v9
  v_fmamk_f32 v97, v8, 0x426c0000, v9
  v_cos_f32 v98, v96
  v_cos_f32 v99, v97
  v_sin_f32 v96, v96
  v_sin_f32 v97, v97
  v_cvt_pk_bf16_f32 v55, v98, v99
  v_cvt_pk_bf16_f32 v71, v96, v97
  v_xor_b32 v32, 0x80008000, v24
  v_xor_b32 v33, 0x80008000, v25
  v_xor_b32 v34, 0x80008000, v26
  v_xor_b32 v35, 0x80008000, v27
  v_xor_b32 v36, 0x80008000, v28
  v_xor_b32 v37, 0x80008000, v29
  v_xor_b32 v38, 0x80008000, v30
  v_xor_b32 v39, 0x80008000, v31
  v_xor_b32 v72, 0x80008000, v56
  v_xor_b32 v73, 0x80008000, v57
  v_xor_b32 v74, 0x80008000, v58
  v_xor_b32 v75, 0x80008000, v59
  v_xor_b32 v76, 0x80008000, v60
  v_xor_b32 v77, 0x80008000, v61
  v_xor_b32 v78, 0x80008000, v62
  v_xor_b32 v79, 0x80008000, v63
  v_xor_b32 v80, 0x80008000, v64
  v_xor_b32 v81, 0x80008000, v65
  v_xor_b32 v82, 0x80008000, v66
  v_xor_b32 v83, 0x80008000, v67
  v_xor_b32 v84, 0x80008000, v68
  v_xor_b32 v85, 0x80008000, v69
  v_xor_b32 v86, 0x80008000, v70
  v_xor_b32 v87, 0x80008000, v71
  v_lshlrev_b32 v5, 4, v2
  v_add_u32 v5, 0x20000, v5
  v_lshl_add_u32 v14, v1, 11, v5
  v_cvt_f32_u32 v10, v1
  v_fmamk_f32 v10, v10, 0x41000000, v7
  v_mul_f32 v8, 0xba000000, v6
  v_add_f32 v9, 0x0, v10
  v_mul_f32 v9, v9, v8
  v_cos_f32 v96, v9
  v_sin_f32 v100, v9
  v_add_f32 v9, 0x3f800000, v10
  v_mul_f32 v9, v9, v8
  v_cos_f32 v97, v9
  v_sin_f32 v101, v9
  v_add_f32 v9, 0x40000000, v10
  v_mul_f32 v9, v9, v8
  v_cos_f32 v98, v9
  v_sin_f32 v102, v9
  v_add_f32 v9, 0x40400000, v10
  v_mul_f32 v9, v9, v8
  v_cos_f32 v99, v9
  v_sin_f32 v103, v9
  v_and_b32 v10, 3, v1
  v_cvt_f32_u32 v10, v10
  v_fmamk_f32 v10, v10, 0x41000000, v7
  v_lshrrev_b32 v8, 2, v1
  v_lshl_add_u32 v8, v8, 5, v12
  v_cvt_f32_u32 v8, v8
  v_mul_f32 v8, 0x3a000000, v8
  v_add_f32 v9, 0x0, v10
  v_mul_f32 v9, v9, v8
  v_cos_f32 v104, v9
  v_sin_f32 v108, v9
  v_add_f32 v9, 0x3f800000, v10
  v_mul_f32 v9, v9, v8
  v_cos_f32 v105, v9
  v_sin_f32 v109, v9
  v_add_f32 v9, 0x40000000, v10
  v_mul_f32 v9, v9, v8
  v_cos_f32 v106, v9
  v_sin_f32 v110, v9
  v_add_f32 v9, 0x40400000, v10
  v_mul_f32 v9, v9, v8
  v_cos_f32 v107, v9
  v_sin_f32 v111, v9
  v_mul_f32 v104, 0x35800000, v104
  v_mul_f32 v105, 0x35800000, v105
  v_mul_f32 v106, 0x35800000, v106
  v_mul_f32 v107, 0x35800000, v107
  v_mul_f32 v108, 0x35800000, v108
  v_mul_f32 v109, 0x35800000, v109
  v_mul_f32 v110, 0x35800000, v110
  v_mul_f32 v111, 0x35800000, v111
  ds_write_b128 v14, v[96:99]
  ds_write_b128 v14, v[100:103] offset:1024
  ds_write_b128 v14, v[104:107] offset:16384
  ds_write_b128 v14, v[108:111] offset:17408
  v_lshl_add_u32 v7, v13, 3, v1
  v_xor_b32 v7, v7, v2
  v_and_b32 v7, 15, v7
  v_lshlrev_b32 v7, 4, v7
  v_lshl_add_u32 v7, v12, 8, v7
  v_add_u32 v7, 0x10000, v7
  v_lshl_add_u32 v8, v13, 6, v12
  v_lshlrev_b32 v8, 8, v8
  v_and_b32 v14, 15, v2
  v_lshl_add_u32 v8, v14, 4, v8
  v_and_b32 v14, 3, v1
  v_lshlrev_b32 v14, 3, v14
  v_xor_b32 v14, v14, v2
  v_lshlrev_b32 v9, 3, v14
  v_lshl_add_u32 v9, v1, 13, v9
  v_add_u32 v9, 0x10000, v9
  v_bfe_u32 v14, v2, 2, 2
  v_mul_u32_u24 v10, 0x2040, v14
  v_lshl_add_u32 v10, v13, 12, v10
  v_lshl_add_u32 v10, v1, 9, v10
  v_bfe_u32 v15, v2, 4, 1
  v_lshl_add_u32 v10, v15, 5, v10
  v_lshl_add_u32 v11, v15, 2, v14
  v_lshlrev_b32 v11, 11, v11
  v_and_b32 v14, 3, v2
  v_lshl_add_u32 v10, v14, 3, v10
  v_add_u32 v10, 0x10000, v10
  v_lshl_add_u32 v11, v14, 4, v11
  v_lshl_add_u32 v11, v1, 8, v11
  v_lshl_add_u32 v11, v13, 6, v11
  s_waitcnt vmcnt(0) lgkmcnt(0)
  s_barrier
  s_and_b32 s24, s21, 7
  s_lshl_b32 s24, s24, 10
  s_add_u32 s24, s24, 73728
  v_lshlrev_b32 v100, 4, v2
  s_cmp_lg_u32 s20, 0
  s_cbranch_scc1 cf_p2_ok
  s_mov_b64 exec, -1
cf_p2:
  buffer_load_dwordx4 v[96:99], v100, s[92:95], s24 offen sc1
  s_waitcnt vmcnt(0)
  v_xor_b32 v97, v97, v98
  v_xor_b32 v98, v98, v99
  v_xor_b32 v99, v99, v96
  v_or3_b32 v97, v97, v98, v99
  v_xor_b32 v96, s88, v96
  v_or_b32 v96, v96, v97
  v_cmp_ne_u32 vcc, 0, v96
  s_nop 4
  s_cbranch_vccnz cf_p2
cf_p2_ok:
  s_mov_b64 exec, -1
  s_barrier
  s_cmp_lg_u32 s2, 224
  s_cbranch_scc1 cf_g
  s_cmp_lg_u32 s20, 1
  s_cbranch_scc1 cf_g
  v_mov_b32 v14, s88
  v_lshlrev_b32 v15, 7, v2
  s_mov_b32 exec_lo, 1
  s_mov_b32 exec_hi, 0
  buffer_store_dword v14, v15, s[92:95], 0 offen sc1
  s_mov_b64 exec, -1
cf_g:
  s_mov_b32 s28, s23
  v_xor_b32 v14, 0, v4
  s_add_u32 m0, s29, 0
  s_nop 0
  buffer_load_dwordx4 v14, s[8:11], s28 offen sc1 lds
  s_add_u32 s28, s28, 0x10000
  v_xor_b32 v14, 64, v4
  s_add_u32 m0, s29, 1024
  s_nop 0
  buffer_load_dwordx4 v14, s[8:11], s28 offen sc1 lds
  s_add_u32 s28, s28, 0x10000
  v_xor_b32 v14, 128, v4
  s_add_u32 m0, s29, 2048
  s_nop 0
  buffer_load_dwordx4 v14, s[8:11], s28 offen sc1 lds
  s_add_u32 s28, s28, 0x10000
  v_xor_b32 v14, 192, v4
  s_add_u32 m0, s29, 3072
  s_nop 0
  buffer_load_dwordx4 v14, s[8:11], s28 offen sc1 lds
  s_add_u32 s28, s28, 0x10000
  v_xor_b32 v14, 0, v4
  s_add_u32 m0, s29, 4096
  s_nop 0
  buffer_load_dwordx4 v14, s[8:11], s28 offen sc1 lds
  s_add_u32 s28, s28, 0x10000
  v_xor_b32 v14, 64, v4
  s_add_u32 m0, s29, 5120
  s_nop 0
  buffer_load_dwordx4 v14, s[8:11], s28 offen sc1 lds
  s_add_u32 s28, s28, 0x10000
  v_xor_b32 v14, 128, v4
  s_add_u32 m0, s29, 6144
  s_nop 0
  buffer_load_dwordx4 v14, s[8:11], s28 offen sc1 lds
  s_add_u32 s28, s28, 0x10000
  v_xor_b32 v14, 192, v4
  s_add_u32 m0, s29, 7168
  s_nop 0
  buffer_load_dwordx4 v14, s[8:11], s28 offen sc1 lds
  s_add_u32 s28, s28, 0x10000
  s_cmp_lt_u32 s20, 4
  s_cbranch_scc0 cf_np
  s_setprio 2
cf_np:
  s_waitcnt vmcnt(0)
cf_loop:
  s_lshl_b32 s28, s20, 5
  s_cmp_eq_u32 s31, 2
  s_cselect_b32 s28, 16, s28
  s_cselect_b32 s48, 0, -1
  s_add_u32 s49, s21, s31
  s_add_u32 s49, s49, s20
  s_cmp_eq_u32 s49, 0
  s_cselect_b32 s48, 0, s48
  v_xor_b32 v6, s28, v8
  v_xor_b32 v15, 16, v6
  s_barrier
  ds_read_b128 v[160:163], v6 offset:0
  ds_read_b128 v[176:179], v15 offset:0
  ds_read_b128 v[164:167], v6 offset:32768
  ds_read_b128 v[180:183], v15 offset:32768
  ds_read_b128 v[168:171], v6 offset:8192
  ds_read_b128 v[184:187], v15 offset:8192
  ds_read_b128 v[172:175], v6 offset:40960
  ds_read_b128 v[188:191], v15 offset:40960
  ds_read_b128 v[192:195], v5
  ds_read_b128 v[196:199], v5 offset:1024
  s_mov_b32 s28, s22
  v_xor_b32 v14, 0, v3
  s_add_u32 m0, s29, 65536
  s_nop 0
  buffer_load_dwordx4 v14, s[12:15], s28 offen sc1 lds
  s_add_u32 s28, s28, 0x10000
  v_xor_b32 v14, 64, v3
  s_add_u32 m0, s29, 66560
  s_nop 0
  buffer_load_dwordx4 v14, s[12:15], s28 offen sc1 lds
  s_add_u32 s28, s28, 0x10000
  v_xor_b32 v14, 8192, v3
  s_add_u32 m0, s29, 67584
  s_nop 0
  buffer_load_dwordx4 v14, s[12:15], s28 offen sc1 lds
  s_add_u32 s28, s28, 0x10000
  v_xor_b32 v14, 8256, v3
  s_add_u32 m0, s29, 68608
  s_nop 0
  buffer_load_dwordx4 v14, s[12:15], s28 offen sc1 lds
  s_add_u32 s28, s28, 0x10000
  v_xor_b32 v14, 0, v3
  s_add_u32 m0, s29, 69632
  s_nop 0
  buffer_load_dwordx4 v14, s[12:15], s28 offen sc1 lds
  s_add_u32 s28, s28, 0x10000
  v_xor_b32 v14, 64, v3
  s_add_u32 m0, s29, 70656
  s_nop 0
  buffer_load_dwordx4 v14, s[12:15], s28 offen sc1 lds
  s_add_u32 s28, s28, 0x10000
  v_xor_b32 v14, 8192, v3
  s_add_u32 m0, s29, 71680
  s_nop 0
  buffer_load_dwordx4 v14, s[12:15], s28 offen sc1 lds
  s_add_u32 s28, s28, 0x10000
  v_xor_b32 v14, 8256, v3
  s_add_u32 m0, s29, 72704
  s_nop 0
  buffer_load_dwordx4 v14, s[12:15], s28 offen sc1 lds
  s_add_u32 s28, s28, 0x10000
  s_cmp_lg_u32 s31, 9
  s_cbranch_scc1 cf_pf
  s_mov_b64 s[36:37], s[46:47]
  s_mov_b32 s45, 0x1f0000
  s_lshl_b32 s24, s21, 16
  s_cselect_b32 s24, s24, 0x40000000
  s_sub_u32 s24, s24, 0x10000
  v_lshlrev_b32 v255, 7, v0
  v_add_u32 v255, s24, v255
cf_pf:
  buffer_load_dword v254, v255, s[36:39], 0 offen
  v_add_u32 v255, s45, v255
  buffer_load_dword v254, v255, s[36:39], 0 offen
  v_add_u32 v255, s45, v255
  s_add_u32 s31, s31, 1
  s_add_u32 s22, s22, 128
  s_add_u32 s23, s23, 256
  s_cmp_eq_u32 s31, 2
  s_cselect_b32 s22, 0x400000, s22
  s_cselect_b32 s23, 0, s23
  s_cmp_lg_u32 s31, 3
  s_cbranch_scc1 cf_comp
  s_cmp_eq_u32 s20, 0
  s_cbranch_scc1 cf_comp
  s_waitcnt vmcnt(0) lgkmcnt(0)
  s_barrier
  s_branch cf_done
cf_comp:
  s_waitcnt lgkmcnt(2)
  s_cmp_lg_u32 s48, 0
  s_cbranch_scc1 cf_nz
  v_mov_b32 v176, 0
  v_mov_b32 v177, 0
  v_mov_b32 v178, 0
  v_mov_b32 v179, 0
  v_mov_b32 v180, 0
  v_mov_b32 v181, 0
  v_mov_b32 v182, 0
  v_mov_b32 v183, 0
  v_mov_b32 v184, 0
  v_mov_b32 v185, 0
  v_mov_b32 v186, 0
  v_mov_b32 v187, 0
  v_mov_b32 v188, 0
  v_mov_b32 v189, 0
  v_mov_b32 v190, 0
  v_mov_b32 v191, 0
  s_nop 1
cf_nz:
  v_mfma_f32_32x32x16_bf16 v[96:111], v[160:163], v[16:19], 0
  v_mfma_f32_32x32x16_bf16 v[128:143], v[176:179], v[16:19], 0
  v_mfma_f32_32x32x16_bf16 v[96:111], v[176:179], v[32:35], v[96:111]
  v_mfma_f32_32x32x16_bf16 v[128:143], v[160:163], v[24:27], v[128:143]
  v_mfma_f32_32x32x16_bf16 v[96:111], v[164:167], v[20:23], v[96:111]
  v_mfma_f32_32x32x16_bf16 v[128:143], v[180:183], v[20:23], v[128:143]
  v_mfma_f32_32x32x16_bf16 v[96:111], v[180:183], v[36:39], v[96:111]
  v_mfma_f32_32x32x16_bf16 v[128:143], v[164:167], v[28:31], v[128:143]
  v_mfma_f32_32x32x16_bf16 v[112:127], v[168:171], v[16:19], 0
  v_mfma_f32_32x32x16_bf16 v[144:159], v[184:187], v[16:19], 0
  v_mfma_f32_32x32x16_bf16 v[112:127], v[184:187], v[32:35], v[112:127]
  v_mfma_f32_32x32x16_bf16 v[144:159], v[168:171], v[24:27], v[144:159]
  v_mfma_f32_32x32x16_bf16 v[112:127], v[172:175], v[20:23], v[112:127]
  v_mfma_f32_32x32x16_bf16 v[144:159], v[188:191], v[20:23], v[144:159]
  v_mfma_f32_32x32x16_bf16 v[112:127], v[188:191], v[36:39], v[112:127]
  v_mfma_f32_32x32x16_bf16 v[144:159], v[172:175], v[28:31], v[144:159]
  ds_read_b128 v[200:203], v5 offset:2048
  ds_read_b128 v[204:207], v5 offset:3072
  s_waitcnt lgkmcnt(2)
  v_pk_mul_f32 v[14:15], v[96:97], v[196:197]
  v_pk_mul_f32 v[96:97], v[96:97], v[192:193]
  v_pk_fma_f32 v[96:97], v[128:129], v[196:197], v[96:97] neg_lo:[1,0,0] neg_hi:[1,0,0]
  v_pk_fma_f32 v[128:129], v[128:129], v[192:193], v[14:15]
  v_pk_mul_f32 v[14:15], v[98:99], v[198:199]
  v_pk_mul_f32 v[98:99], v[98:99], v[194:195]
  v_pk_fma_f32 v[98:99], v[130:131], v[198:199], v[98:99] neg_lo:[1,0,0] neg_hi:[1,0,0]
  v_pk_fma_f32 v[130:131], v[130:131], v[194:195], v[14:15]
  ds_read_b128 v[192:195], v5 offset:4096
  ds_read_b128 v[196:199], v5 offset:5120
  s_waitcnt lgkmcnt(2)
  v_pk_mul_f32 v[14:15], v[100:101], v[204:205]
  v_pk_mul_f32 v[100:101], v[100:101], v[200:201]
  v_pk_fma_f32 v[100:101], v[132:133], v[204:205], v[100:101] neg_lo:[1,0,0] neg_hi:[1,0,0]
  v_pk_fma_f32 v[132:133], v[132:133], v[200:201], v[14:15]
  v_pk_mul_f32 v[14:15], v[102:103], v[206:207]
  v_pk_mul_f32 v[102:103], v[102:103], v[202:203]
  v_pk_fma_f32 v[102:103], v[134:135], v[206:207], v[102:103] neg_lo:[1,0,0] neg_hi:[1,0,0]
  v_pk_fma_f32 v[134:135], v[134:135], v[202:203], v[14:15]
  ds_read_b128 v[200:203], v5 offset:6144
  ds_read_b128 v[204:207], v5 offset:7168
  s_waitcnt lgkmcnt(2)
  v_pk_mul_f32 v[14:15], v[104:105], v[196:197]
  v_pk_mul_f32 v[104:105], v[104:105], v[192:193]
  v_pk_fma_f32 v[104:105], v[136:137], v[196:197], v[104:105] neg_lo:[1,0,0] neg_hi:[1,0,0]
  v_pk_fma_f32 v[136:137], v[136:137], v[192:193], v[14:15]
  v_pk_mul_f32 v[14:15], v[106:107], v[198:199]
  v_pk_mul_f32 v[106:107], v[106:107], v[194:195]
  v_pk_fma_f32 v[106:107], v[138:139], v[198:199], v[106:107] neg_lo:[1,0,0] neg_hi:[1,0,0]
  v_pk_fma_f32 v[138:139], v[138:139], v[194:195], v[14:15]
  ds_read_b128 v[192:195], v5 offset:8192
  ds_read_b128 v[196:199], v5 offset:9216
  s_waitcnt lgkmcnt(2)
  v_pk_mul_f32 v[14:15], v[108:109], v[204:205]
  v_pk_mul_f32 v[108:109], v[108:109], v[200:201]
  v_pk_fma_f32 v[108:109], v[140:141], v[204:205], v[108:109] neg_lo:[1,0,0] neg_hi:[1,0,0]
  v_pk_fma_f32 v[140:141], v[140:141], v[200:201], v[14:15]
  v_pk_mul_f32 v[14:15], v[110:111], v[206:207]
  v_pk_mul_f32 v[110:111], v[110:111], v[202:203]
  v_pk_fma_f32 v[110:111], v[142:143], v[206:207], v[110:111] neg_lo:[1,0,0] neg_hi:[1,0,0]
  v_pk_fma_f32 v[142:143], v[142:143], v[202:203], v[14:15]
  ds_read_b128 v[200:203], v5 offset:10240
  ds_read_b128 v[204:207], v5 offset:11264
  s_waitcnt lgkmcnt(2)
  v_pk_mul_f32 v[14:15], v[112:113], v[196:197]
  v_pk_mul_f32 v[112:113], v[112:113], v[192:193]
  v_pk_fma_f32 v[112:113], v[144:145], v[196:197], v[112:113] neg_lo:[1,0,0] neg_hi:[1,0,0]
  v_pk_fma_f32 v[144:145], v[144:145], v[192:193], v[14:15]
  v_pk_mul_f32 v[14:15], v[114:115], v[198:199]
  v_pk_mul_f32 v[114:115], v[114:115], v[194:195]
  v_pk_fma_f32 v[114:115], v[146:147], v[198:199], v[114:115] neg_lo:[1,0,0] neg_hi:[1,0,0]
  v_pk_fma_f32 v[146:147], v[146:147], v[194:195], v[14:15]
  ds_read_b128 v[192:195], v5 offset:12288
  ds_read_b128 v[196:199], v5 offset:13312
  s_waitcnt lgkmcnt(2)
  v_pk_mul_f32 v[14:15], v[116:117], v[204:205]
  v_pk_mul_f32 v[116:117], v[116:117], v[200:201]
  v_pk_fma_f32 v[116:117], v[148:149], v[204:205], v[116:117] neg_lo:[1,0,0] neg_hi:[1,0,0]
  v_pk_fma_f32 v[148:149], v[148:149], v[200:201], v[14:15]
  v_pk_mul_f32 v[14:15], v[118:119], v[206:207]
  v_pk_mul_f32 v[118:119], v[118:119], v[202:203]
  v_pk_fma_f32 v[118:119], v[150:151], v[206:207], v[118:119] neg_lo:[1,0,0] neg_hi:[1,0,0]
  v_pk_fma_f32 v[150:151], v[150:151], v[202:203], v[14:15]
  ds_read_b128 v[200:203], v5 offset:14336
  ds_read_b128 v[204:207], v5 offset:15360
  s_waitcnt lgkmcnt(2)
  v_pk_mul_f32 v[14:15], v[120:121], v[196:197]
  v_pk_mul_f32 v[120:121], v[120:121], v[192:193]
  v_pk_fma_f32 v[120:121], v[152:153], v[196:197], v[120:121] neg_lo:[1,0,0] neg_hi:[1,0,0]
  v_pk_fma_f32 v[152:153], v[152:153], v[192:193], v[14:15]
  v_pk_mul_f32 v[14:15], v[122:123], v[198:199]
  v_pk_mul_f32 v[122:123], v[122:123], v[194:195]
  v_pk_fma_f32 v[122:123], v[154:155], v[198:199], v[122:123] neg_lo:[1,0,0] neg_hi:[1,0,0]
  v_pk_fma_f32 v[154:155], v[154:155], v[194:195], v[14:15]
  s_waitcnt lgkmcnt(0)
  v_pk_mul_f32 v[14:15], v[124:125], v[204:205]
  v_pk_mul_f32 v[124:125], v[124:125], v[200:201]
  v_pk_fma_f32 v[124:125], v[156:157], v[204:205], v[124:125] neg_lo:[1,0,0] neg_hi:[1,0,0]
  v_pk_fma_f32 v[156:157], v[156:157], v[200:201], v[14:15]
  v_pk_mul_f32 v[14:15], v[126:127], v[206:207]
  v_pk_mul_f32 v[126:127], v[126:127], v[202:203]
  v_pk_fma_f32 v[126:127], v[158:159], v[206:207], v[126:127] neg_lo:[1,0,0] neg_hi:[1,0,0]
  v_pk_fma_f32 v[158:159], v[158:159], v[202:203], v[14:15]
  v_cvt_pk_bf16_f32 v160, v96, v98
  v_cvt_pk_bf16_f32 v176, v128, v130
  v_cvt_pk_bf16_f32 v161, v100, v102
  v_cvt_pk_bf16_f32 v177, v132, v134
  v_cvt_pk_bf16_f32 v162, v104, v106
  v_cvt_pk_bf16_f32 v178, v136, v138
  v_cvt_pk_bf16_f32 v163, v108, v110
  v_cvt_pk_bf16_f32 v179, v140, v142
  v_cvt_pk_bf16_f32 v168, v97, v99
  v_cvt_pk_bf16_f32 v184, v129, v131
  v_cvt_pk_bf16_f32 v169, v101, v103
  v_cvt_pk_bf16_f32 v185, v133, v135
  v_cvt_pk_bf16_f32 v170, v105, v107
  v_cvt_pk_bf16_f32 v186, v137, v139
  v_cvt_pk_bf16_f32 v171, v109, v111
  v_cvt_pk_bf16_f32 v187, v141, v143
  v_cvt_pk_bf16_f32 v164, v112, v114
  v_cvt_pk_bf16_f32 v180, v144, v146
  v_cvt_pk_bf16_f32 v165, v116, v118
  v_cvt_pk_bf16_f32 v181, v148, v150
  v_cvt_pk_bf16_f32 v166, v120, v122
  v_cvt_pk_bf16_f32 v182, v152, v154
  v_cvt_pk_bf16_f32 v167, v124, v126
  v_cvt_pk_bf16_f32 v183, v156, v158
  v_cvt_pk_bf16_f32 v172, v113, v115
  v_cvt_pk_bf16_f32 v188, v145, v147
  v_cvt_pk_bf16_f32 v173, v117, v119
  v_cvt_pk_bf16_f32 v189, v149, v151
  v_cvt_pk_bf16_f32 v174, v121, v123
  v_cvt_pk_bf16_f32 v190, v153, v155
  v_cvt_pk_bf16_f32 v175, v125, v127
  v_cvt_pk_bf16_f32 v191, v157, v159
  v_mfma_f32_32x32x16_bf16 v[96:111], v[40:43], v[160:163], 0
  v_mfma_f32_32x32x16_bf16 v[128:143], v[40:43], v[176:179], 0
  v_mfma_f32_32x32x16_bf16 v[96:111], v[72:75], v[176:179], v[96:111]
  v_mfma_f32_32x32x16_bf16 v[128:143], v[56:59], v[160:163], v[128:143]
  v_mfma_f32_32x32x16_bf16 v[96:111], v[44:47], v[164:167], v[96:111]
  v_mfma_f32_32x32x16_bf16 v[128:143], v[44:47], v[180:183], v[128:143]
  v_mfma_f32_32x32x16_bf16 v[96:111], v[76:79], v[180:183], v[96:111]
  v_mfma_f32_32x32x16_bf16 v[128:143], v[60:63], v[164:167], v[128:143]
  v_mfma_f32_32x32x16_bf16 v[112:127], v[48:51], v[168:171], 0
  v_mfma_f32_32x32x16_bf16 v[144:159], v[48:51], v[184:187], 0
  v_mfma_f32_32x32x16_bf16 v[112:127], v[80:83], v[184:187], v[112:127]
  v_mfma_f32_32x32x16_bf16 v[144:159], v[64:67], v[168:171], v[144:159]
  v_mfma_f32_32x32x16_bf16 v[112:127], v[52:55], v[172:175], v[112:127]
  v_mfma_f32_32x32x16_bf16 v[144:159], v[52:55], v[188:191], v[144:159]
  v_mfma_f32_32x32x16_bf16 v[112:127], v[84:87], v[188:191], v[112:127]
  v_mfma_f32_32x32x16_bf16 v[144:159], v[68:71], v[172:175], v[144:159]
  s_nop 10
  v_pk_add_f32 v[96:97], v[96:97], v[112:113]
  v_pk_fma_f32 v[112:113], v[112:113], v[88:89], v[96:97]
  v_pk_add_f32 v[98:99], v[98:99], v[114:115]
  v_pk_fma_f32 v[114:115], v[114:115], v[88:89], v[98:99]
  v_pk_add_f32 v[100:101], v[100:101], v[116:117]
  v_pk_fma_f32 v[116:117], v[116:117], v[88:89], v[100:101]
  v_pk_add_f32 v[102:103], v[102:103], v[118:119]
  v_pk_fma_f32 v[118:119], v[118:119], v[88:89], v[102:103]
  v_pk_add_f32 v[104:105], v[104:105], v[120:121]
  v_pk_fma_f32 v[120:121], v[120:121], v[88:89], v[104:105]
  v_pk_add_f32 v[106:107], v[106:107], v[122:123]
  v_pk_fma_f32 v[122:123], v[122:123], v[88:89], v[106:107]
  v_pk_add_f32 v[108:109], v[108:109], v[124:125]
  v_pk_fma_f32 v[124:125], v[124:125], v[88:89], v[108:109]
  v_pk_add_f32 v[110:111], v[110:111], v[126:127]
  v_pk_fma_f32 v[126:127], v[126:127], v[88:89], v[110:111]
  v_pk_add_f32 v[128:129], v[128:129], v[144:145]
  v_pk_fma_f32 v[144:145], v[144:145], v[88:89], v[128:129]
  v_pk_add_f32 v[130:131], v[130:131], v[146:147]
  v_pk_fma_f32 v[146:147], v[146:147], v[88:89], v[130:131]
  v_pk_add_f32 v[132:133], v[132:133], v[148:149]
  v_pk_fma_f32 v[148:149], v[148:149], v[88:89], v[132:133]
  v_pk_add_f32 v[134:135], v[134:135], v[150:151]
  v_pk_fma_f32 v[150:151], v[150:151], v[88:89], v[134:135]
  v_pk_add_f32 v[136:137], v[136:137], v[152:153]
  v_pk_fma_f32 v[152:153], v[152:153], v[88:89], v[136:137]
  v_pk_add_f32 v[138:139], v[138:139], v[154:155]
  v_pk_fma_f32 v[154:155], v[154:155], v[88:89], v[138:139]
  v_pk_add_f32 v[140:141], v[140:141], v[156:157]
  v_pk_fma_f32 v[156:157], v[156:157], v[88:89], v[140:141]
  v_pk_add_f32 v[142:143], v[142:143], v[158:159]
  v_pk_fma_f32 v[158:159], v[158:159], v[88:89], v[142:143]
  s_waitcnt vmcnt(2)
  s_barrier
  ds_read_b128 v[192:195], v7
  s_mov_b32 s28, s23
  v_xor_b32 v14, 0, v4
  s_add_u32 m0, s29, 0
  s_nop 0
  buffer_load_dwordx4 v14, s[8:11], s28 offen sc1 lds
  s_add_u32 s28, s28, 0x10000
  v_xor_b32 v14, 64, v4
  s_add_u32 m0, s29, 1024
  s_nop 0
  buffer_load_dwordx4 v14, s[8:11], s28 offen sc1 lds
  s_add_u32 s28, s28, 0x10000
  v_xor_b32 v14, 128, v4
  s_add_u32 m0, s29, 2048
  s_nop 0
  buffer_load_dwordx4 v14, s[8:11], s28 offen sc1 lds
  s_add_u32 s28, s28, 0x10000
  v_xor_b32 v14, 192, v4
  s_add_u32 m0, s29, 3072
  s_nop 0
  buffer_load_dwordx4 v14, s[8:11], s28 offen sc1 lds
  s_add_u32 s28, s28, 0x10000
  v_xor_b32 v14, 0, v4
  s_add_u32 m0, s29, 4096
  s_nop 0
  buffer_load_dwordx4 v14, s[8:11], s28 offen sc1 lds
  s_add_u32 s28, s28, 0x10000
  v_xor_b32 v14, 64, v4
  s_add_u32 m0, s29, 5120
  s_nop 0
  buffer_load_dwordx4 v14, s[8:11], s28 offen sc1 lds
  s_add_u32 s28, s28, 0x10000
  v_xor_b32 v14, 128, v4
  s_add_u32 m0, s29, 6144
  s_nop 0
  buffer_load_dwordx4 v14, s[8:11], s28 offen sc1 lds
  s_add_u32 s28, s28, 0x10000
  v_xor_b32 v14, 192, v4
  s_add_u32 m0, s29, 7168
  s_nop 0
  buffer_load_dwordx4 v14, s[8:11], s28 offen sc1 lds
  s_add_u32 s28, s28, 0x10000
  buffer_load_dword v254, v255, s[36:39], 0 offen
  v_add_u32 v255, s45, v255
  buffer_load_dword v254, v255, s[36:39], 0 offen
  v_add_u32 v255, s45, v255
  ds_read_b128 v[196:199], v7 offset:8192
  s_waitcnt lgkmcnt(1)
  v_lshlrev_b32 v200, 16, v192
  v_and_b32 v201, 0xffff0000, v192
  v_lshlrev_b32 v202, 16, v193
  v_and_b32 v203, 0xffff0000, v193
  v_lshlrev_b32 v204, 16, v194
  v_and_b32 v205, 0xffff0000, v194
  v_lshlrev_b32 v206, 16, v195
  v_and_b32 v207, 0xffff0000, v195
  v_pk_mul_f32 v[14:15], v[96:97], v[204:205]
  v_pk_mul_f32 v[96:97], v[96:97], v[200:201]
  v_pk_fma_f32 v[96:97], v[128:129], v[204:205], v[96:97] neg_lo:[1,0,0] neg_hi:[1,0,0]
  v_pk_fma_f32 v[128:129], v[128:129], v[200:201], v[14:15]
  v_pk_mul_f32 v[14:15], v[98:99], v[206:207]
  v_pk_mul_f32 v[98:99], v[98:99], v[202:203]
  v_pk_fma_f32 v[98:99], v[130:131], v[206:207], v[98:99] neg_lo:[1,0,0] neg_hi:[1,0,0]
  v_pk_fma_f32 v[130:131], v[130:131], v[202:203], v[14:15]
  ds_read_b128 v[192:195], v7 offset:16384
  s_waitcnt lgkmcnt(1)
  v_lshlrev_b32 v200, 16, v196
  v_and_b32 v201, 0xffff0000, v196
  v_lshlrev_b32 v202, 16, v197
  v_and_b32 v203, 0xffff0000, v197
  v_lshlrev_b32 v204, 16, v198
  v_and_b32 v205, 0xffff0000, v198
  v_lshlrev_b32 v206, 16, v199
  v_and_b32 v207, 0xffff0000, v199
  v_pk_mul_f32 v[14:15], v[100:101], v[204:205]
  v_pk_mul_f32 v[100:101], v[100:101], v[200:201]
  v_pk_fma_f32 v[100:101], v[132:133], v[204:205], v[100:101] neg_lo:[1,0,0] neg_hi:[1,0,0]
  v_pk_fma_f32 v[132:133], v[132:133], v[200:201], v[14:15]
  v_pk_mul_f32 v[14:15], v[102:103], v[206:207]
  v_pk_mul_f32 v[102:103], v[102:103], v[202:203]
  v_pk_fma_f32 v[102:103], v[134:135], v[206:207], v[102:103] neg_lo:[1,0,0] neg_hi:[1,0,0]
  v_pk_fma_f32 v[134:135], v[134:135], v[202:203], v[14:15]
  ds_read_b128 v[196:199], v7 offset:24576
  s_waitcnt lgkmcnt(1)
  v_lshlrev_b32 v200, 16, v192
  v_and_b32 v201, 0xffff0000, v192
  v_lshlrev_b32 v202, 16, v193
  v_and_b32 v203, 0xffff0000, v193
  v_lshlrev_b32 v204, 16, v194
  v_and_b32 v205, 0xffff0000, v194
  v_lshlrev_b32 v206, 16, v195
  v_and_b32 v207, 0xffff0000, v195
  v_pk_mul_f32 v[14:15], v[104:105], v[204:205]
  v_pk_mul_f32 v[104:105], v[104:105], v[200:201]
  v_pk_fma_f32 v[104:105], v[136:137], v[204:205], v[104:105] neg_lo:[1,0,0] neg_hi:[1,0,0]
  v_pk_fma_f32 v[136:137], v[136:137], v[200:201], v[14:15]
  v_pk_mul_f32 v[14:15], v[106:107], v[206:207]
  v_pk_mul_f32 v[106:107], v[106:107], v[202:203]
  v_pk_fma_f32 v[106:107], v[138:139], v[206:207], v[106:107] neg_lo:[1,0,0] neg_hi:[1,0,0]
  v_pk_fma_f32 v[138:139], v[138:139], v[202:203], v[14:15]
  ds_read_b128 v[192:195], v7 offset:32768
  s_waitcnt lgkmcnt(1)
  v_lshlrev_b32 v200, 16, v196
  v_and_b32 v201, 0xffff0000, v196
  v_lshlrev_b32 v202, 16, v197
  v_and_b32 v203, 0xffff0000, v197
  v_lshlrev_b32 v204, 16, v198
  v_and_b32 v205, 0xffff0000, v198
  v_lshlrev_b32 v206, 16, v199
  v_and_b32 v207, 0xffff0000, v199
  v_pk_mul_f32 v[14:15], v[108:109], v[204:205]
  v_pk_mul_f32 v[108:109], v[108:109], v[200:201]
  v_pk_fma_f32 v[108:109], v[140:141], v[204:205], v[108:109] neg_lo:[1,0,0] neg_hi:[1,0,0]
  v_pk_fma_f32 v[140:141], v[140:141], v[200:201], v[14:15]
  v_pk_mul_f32 v[14:15], v[110:111], v[206:207]
  v_pk_mul_f32 v[110:111], v[110:111], v[202:203]
  v_pk_fma_f32 v[110:111], v[142:143], v[206:207], v[110:111] neg_lo:[1,0,0] neg_hi:[1,0,0]
  v_pk_fma_f32 v[142:143], v[142:143], v[202:203], v[14:15]
  ds_read_b128 v[196:199], v7 offset:40960
  s_waitcnt lgkmcnt(1)
  v_lshlrev_b32 v200, 16, v192
  v_and_b32 v201, 0xffff0000, v192
  v_lshlrev_b32 v202, 16, v193
  v_and_b32 v203, 0xffff0000, v193
  v_lshlrev_b32 v204, 16, v194
  v_and_b32 v205, 0xffff0000, v194
  v_lshlrev_b32 v206, 16, v195
  v_and_b32 v207, 0xffff0000, v195
  v_pk_mul_f32 v[14:15], v[112:113], v[204:205]
  v_pk_mul_f32 v[112:113], v[112:113], v[200:201]
  v_pk_fma_f32 v[112:113], v[144:145], v[204:205], v[112:113] neg_lo:[1,0,0] neg_hi:[1,0,0]
  v_pk_fma_f32 v[144:145], v[144:145], v[200:201], v[14:15]
  v_pk_mul_f32 v[14:15], v[114:115], v[206:207]
  v_pk_mul_f32 v[114:115], v[114:115], v[202:203]
  v_pk_fma_f32 v[114:115], v[146:147], v[206:207], v[114:115] neg_lo:[1,0,0] neg_hi:[1,0,0]
  v_pk_fma_f32 v[146:147], v[146:147], v[202:203], v[14:15]
  ds_read_b128 v[192:195], v7 offset:49152
  s_waitcnt lgkmcnt(1)
  v_lshlrev_b32 v200, 16, v196
  v_and_b32 v201, 0xffff0000, v196
  v_lshlrev_b32 v202, 16, v197
  v_and_b32 v203, 0xffff0000, v197
  v_lshlrev_b32 v204, 16, v198
  v_and_b32 v205, 0xffff0000, v198
  v_lshlrev_b32 v206, 16, v199
  v_and_b32 v207, 0xffff0000, v199
  v_pk_mul_f32 v[14:15], v[116:117], v[204:205]
  v_pk_mul_f32 v[116:117], v[116:117], v[200:201]
  v_pk_fma_f32 v[116:117], v[148:149], v[204:205], v[116:117] neg_lo:[1,0,0] neg_hi:[1,0,0]
  v_pk_fma_f32 v[148:149], v[148:149], v[200:201], v[14:15]
  v_pk_mul_f32 v[14:15], v[118:119], v[206:207]
  v_pk_mul_f32 v[118:119], v[118:119], v[202:203]
  v_pk_fma_f32 v[118:119], v[150:151], v[206:207], v[118:119] neg_lo:[1,0,0] neg_hi:[1,0,0]
  v_pk_fma_f32 v[150:151], v[150:151], v[202:203], v[14:15]
  ds_read_b128 v[196:199], v7 offset:57344
  s_waitcnt lgkmcnt(1)
  v_lshlrev_b32 v200, 16, v192
  v_and_b32 v201, 0xffff0000, v192
  v_lshlrev_b32 v202, 16, v193
  v_and_b32 v203, 0xffff0000, v193
  v_lshlrev_b32 v204, 16, v194
  v_and_b32 v205, 0xffff0000, v194
  v_lshlrev_b32 v206, 16, v195
  v_and_b32 v207, 0xffff0000, v195
  v_pk_mul_f32 v[14:15], v[120:121], v[204:205]
  v_pk_mul_f32 v[120:121], v[120:121], v[200:201]
  v_pk_fma_f32 v[120:121], v[152:153], v[204:205], v[120:121] neg_lo:[1,0,0] neg_hi:[1,0,0]
  v_pk_fma_f32 v[152:153], v[152:153], v[200:201], v[14:15]
  v_pk_mul_f32 v[14:15], v[122:123], v[206:207]
  v_pk_mul_f32 v[122:123], v[122:123], v[202:203]
  v_pk_fma_f32 v[122:123], v[154:155], v[206:207], v[122:123] neg_lo:[1,0,0] neg_hi:[1,0,0]
  v_pk_fma_f32 v[154:155], v[154:155], v[202:203], v[14:15]
  s_waitcnt lgkmcnt(0)
  v_lshlrev_b32 v200, 16, v196
  v_and_b32 v201, 0xffff0000, v196
  v_lshlrev_b32 v202, 16, v197
  v_and_b32 v203, 0xffff0000, v197
  v_lshlrev_b32 v204, 16, v198
  v_and_b32 v205, 0xffff0000, v198
  v_lshlrev_b32 v206, 16, v199
  v_and_b32 v207, 0xffff0000, v199
  v_pk_mul_f32 v[14:15], v[124:125], v[204:205]
  v_pk_mul_f32 v[124:125], v[124:125], v[200:201]
  v_pk_fma_f32 v[124:125], v[156:157], v[204:205], v[124:125] neg_lo:[1,0,0] neg_hi:[1,0,0]
  v_pk_fma_f32 v[156:157], v[156:157], v[200:201], v[14:15]
  v_pk_mul_f32 v[14:15], v[126:127], v[206:207]
  v_pk_mul_f32 v[126:127], v[126:127], v[202:203]
  v_pk_fma_f32 v[126:127], v[158:159], v[206:207], v[126:127] neg_lo:[1,0,0] neg_hi:[1,0,0]
  v_pk_fma_f32 v[158:159], v[158:159], v[202:203], v[14:15]
  ds_read_b128 v[192:195], v5 offset:16384
  ds_read_b128 v[196:199], v5 offset:17408
  v_cvt_pk_bf16_f32 v160, v96, v98
  v_cvt_pk_bf16_f32 v176, v128, v130
  v_cvt_pk_bf16_f32 v161, v100, v102
  v_cvt_pk_bf16_f32 v177, v132, v134
  v_cvt_pk_bf16_f32 v162, v104, v106
  v_cvt_pk_bf16_f32 v178, v136, v138
  v_cvt_pk_bf16_f32 v163, v108, v110
  v_cvt_pk_bf16_f32 v179, v140, v142
  v_cvt_pk_bf16_f32 v168, v97, v99
  v_cvt_pk_bf16_f32 v184, v129, v131
  v_cvt_pk_bf16_f32 v169, v101, v103
  v_cvt_pk_bf16_f32 v185, v133, v135
  v_cvt_pk_bf16_f32 v170, v105, v107
  v_cvt_pk_bf16_f32 v186, v137, v139
  v_cvt_pk_bf16_f32 v171, v109, v111
  v_cvt_pk_bf16_f32 v187, v141, v143
  v_cvt_pk_bf16_f32 v164, v112, v114
  v_cvt_pk_bf16_f32 v180, v144, v146
  v_cvt_pk_bf16_f32 v165, v116, v118
  v_cvt_pk_bf16_f32 v181, v148, v150
  v_cvt_pk_bf16_f32 v166, v120, v122
  v_cvt_pk_bf16_f32 v182, v152, v154
  v_cvt_pk_bf16_f32 v167, v124, v126
  v_cvt_pk_bf16_f32 v183, v156, v158
  v_cvt_pk_bf16_f32 v172, v113, v115
  v_cvt_pk_bf16_f32 v188, v145, v147
  v_cvt_pk_bf16_f32 v173, v117, v119
  v_cvt_pk_bf16_f32 v189, v149, v151
  v_cvt_pk_bf16_f32 v174, v121, v123
  v_cvt_pk_bf16_f32 v190, v153, v155
  v_cvt_pk_bf16_f32 v175, v125, v127
  v_cvt_pk_bf16_f32 v191, v157, v159
  v_mfma_f32_32x32x16_bf16 v[96:111], v[160:163], v[40:43], 0
  v_mfma_f32_32x32x16_bf16 v[128:143], v[176:179], v[40:43], 0
  v_mfma_f32_32x32x16_bf16 v[96:111], v[176:179], v[56:59], v[96:111]
  v_mfma_f32_32x32x16_bf16 v[128:143], v[160:163], v[72:75], v[128:143]
  v_mfma_f32_32x32x16_bf16 v[96:111], v[164:167], v[44:47], v[96:111]
  v_mfma_f32_32x32x16_bf16 v[128:143], v[180:183], v[44:47], v[128:143]
  v_mfma_f32_32x32x16_bf16 v[96:111], v[180:183], v[60:63], v[96:111]
  v_mfma_f32_32x32x16_bf16 v[128:143], v[164:167], v[76:79], v[128:143]
  v_mfma_f32_32x32x16_bf16 v[112:127], v[168:171], v[48:51], 0
  v_mfma_f32_32x32x16_bf16 v[144:159], v[184:187], v[48:51], 0
  v_mfma_f32_32x32x16_bf16 v[112:127], v[184:187], v[64:67], v[112:127]
  v_mfma_f32_32x32x16_bf16 v[144:159], v[168:171], v[80:83], v[144:159]
  v_mfma_f32_32x32x16_bf16 v[112:127], v[172:175], v[52:55], v[112:127]
  v_mfma_f32_32x32x16_bf16 v[144:159], v[188:191], v[52:55], v[144:159]
  v_mfma_f32_32x32x16_bf16 v[112:127], v[188:191], v[68:71], v[112:127]
  v_mfma_f32_32x32x16_bf16 v[144:159], v[172:175], v[84:87], v[144:159]
  s_nop 10
  v_pk_add_f32 v[96:97], v[96:97], v[112:113]
  v_pk_fma_f32 v[112:113], v[112:113], v[88:89], v[96:97]
  v_pk_add_f32 v[98:99], v[98:99], v[114:115]
  v_pk_fma_f32 v[114:115], v[114:115], v[88:89], v[98:99]
  v_pk_add_f32 v[100:101], v[100:101], v[116:117]
  v_pk_fma_f32 v[116:117], v[116:117], v[88:89], v[100:101]
  v_pk_add_f32 v[102:103], v[102:103], v[118:119]
  v_pk_fma_f32 v[118:119], v[118:119], v[88:89], v[102:103]
  v_pk_add_f32 v[104:105], v[104:105], v[120:121]
  v_pk_fma_f32 v[120:121], v[120:121], v[88:89], v[104:105]
  v_pk_add_f32 v[106:107], v[106:107], v[122:123]
  v_pk_fma_f32 v[122:123], v[122:123], v[88:89], v[106:107]
  v_pk_add_f32 v[108:109], v[108:109], v[124:125]
  v_pk_fma_f32 v[124:125], v[124:125], v[88:89], v[108:109]
  v_pk_add_f32 v[110:111], v[110:111], v[126:127]
  v_pk_fma_f32 v[126:127], v[126:127], v[88:89], v[110:111]
  v_pk_add_f32 v[128:129], v[128:129], v[144:145]
  v_pk_fma_f32 v[144:145], v[144:145], v[88:89], v[128:129]
  v_pk_add_f32 v[130:131], v[130:131], v[146:147]
  v_pk_fma_f32 v[146:147], v[146:147], v[88:89], v[130:131]
  v_pk_add_f32 v[132:133], v[132:133], v[148:149]
  v_pk_fma_f32 v[148:149], v[148:149], v[88:89], v[132:133]
  v_pk_add_f32 v[134:135], v[134:135], v[150:151]
  v_pk_fma_f32 v[150:151], v[150:151], v[88:89], v[134:135]
  v_pk_add_f32 v[136:137], v[136:137], v[152:153]
  v_pk_fma_f32 v[152:153], v[152:153], v[88:89], v[136:137]
  v_pk_add_f32 v[138:139], v[138:139], v[154:155]
  v_pk_fma_f32 v[154:155], v[154:155], v[88:89], v[138:139]
  v_pk_add_f32 v[140:141], v[140:141], v[156:157]
  v_pk_fma_f32 v[156:157], v[156:157], v[88:89], v[140:141]
  v_pk_add_f32 v[142:143], v[142:143], v[158:159]
  v_pk_fma_f32 v[158:159], v[158:159], v[88:89], v[142:143]
  ds_read_b128 v[200:203], v5 offset:18432
  ds_read_b128 v[204:207], v5 offset:19456
  s_waitcnt lgkmcnt(2)
  v_pk_mul_f32 v[14:15], v[96:97], v[196:197]
  v_pk_mul_f32 v[96:97], v[96:97], v[192:193]
  v_pk_fma_f32 v[96:97], v[128:129], v[196:197], v[96:97] neg_lo:[1,0,0] neg_hi:[1,0,0]
  v_pk_fma_f32 v[128:129], v[128:129], v[192:193], v[14:15]
  v_pk_mul_f32 v[14:15], v[98:99], v[198:199]
  v_pk_mul_f32 v[98:99], v[98:99], v[194:195]
  v_pk_fma_f32 v[98:99], v[130:131], v[198:199], v[98:99] neg_lo:[1,0,0] neg_hi:[1,0,0]
  v_pk_fma_f32 v[130:131], v[130:131], v[194:195], v[14:15]
  ds_read_b128 v[192:195], v5 offset:20480
  ds_read_b128 v[196:199], v5 offset:21504
  s_waitcnt lgkmcnt(2)
  v_pk_mul_f32 v[14:15], v[100:101], v[204:205]
  v_pk_mul_f32 v[100:101], v[100:101], v[200:201]
  v_pk_fma_f32 v[100:101], v[132:133], v[204:205], v[100:101] neg_lo:[1,0,0] neg_hi:[1,0,0]
  v_pk_fma_f32 v[132:133], v[132:133], v[200:201], v[14:15]
  v_pk_mul_f32 v[14:15], v[102:103], v[206:207]
  v_pk_mul_f32 v[102:103], v[102:103], v[202:203]
  v_pk_fma_f32 v[102:103], v[134:135], v[206:207], v[102:103] neg_lo:[1,0,0] neg_hi:[1,0,0]
  v_pk_fma_f32 v[134:135], v[134:135], v[202:203], v[14:15]
  ds_read_b128 v[200:203], v5 offset:22528
  ds_read_b128 v[204:207], v5 offset:23552
  s_waitcnt lgkmcnt(2)
  v_pk_mul_f32 v[14:15], v[104:105], v[196:197]
  v_pk_mul_f32 v[104:105], v[104:105], v[192:193]
  v_pk_fma_f32 v[104:105], v[136:137], v[196:197], v[104:105] neg_lo:[1,0,0] neg_hi:[1,0,0]
  v_pk_fma_f32 v[136:137], v[136:137], v[192:193], v[14:15]
  v_pk_mul_f32 v[14:15], v[106:107], v[198:199]
  v_pk_mul_f32 v[106:107], v[106:107], v[194:195]
  v_pk_fma_f32 v[106:107], v[138:139], v[198:199], v[106:107] neg_lo:[1,0,0] neg_hi:[1,0,0]
  v_pk_fma_f32 v[138:139], v[138:139], v[194:195], v[14:15]
  ds_read_b128 v[192:195], v5 offset:24576
  ds_read_b128 v[196:199], v5 offset:25600
  s_waitcnt lgkmcnt(2)
  v_pk_mul_f32 v[14:15], v[108:109], v[204:205]
  v_pk_mul_f32 v[108:109], v[108:109], v[200:201]
  v_pk_fma_f32 v[108:109], v[140:141], v[204:205], v[108:109] neg_lo:[1,0,0] neg_hi:[1,0,0]
  v_pk_fma_f32 v[140:141], v[140:141], v[200:201], v[14:15]
  v_pk_mul_f32 v[14:15], v[110:111], v[206:207]
  v_pk_mul_f32 v[110:111], v[110:111], v[202:203]
  v_pk_fma_f32 v[110:111], v[142:143], v[206:207], v[110:111] neg_lo:[1,0,0] neg_hi:[1,0,0]
  v_pk_fma_f32 v[142:143], v[142:143], v[202:203], v[14:15]
  ds_read_b128 v[200:203], v5 offset:26624
  ds_read_b128 v[204:207], v5 offset:27648
  s_waitcnt lgkmcnt(2)
  v_pk_mul_f32 v[14:15], v[112:113], v[196:197]
  v_pk_mul_f32 v[112:113], v[112:113], v[192:193]
  v_pk_fma_f32 v[112:113], v[144:145], v[196:197], v[112:113] neg_lo:[1,0,0] neg_hi:[1,0,0]
  v_pk_fma_f32 v[144:145], v[144:145], v[192:193], v[14:15]
  v_pk_mul_f32 v[14:15], v[114:115], v[198:199]
  v_pk_mul_f32 v[114:115], v[114:115], v[194:195]
  v_pk_fma_f32 v[114:115], v[146:147], v[198:199], v[114:115] neg_lo:[1,0,0] neg_hi:[1,0,0]
  v_pk_fma_f32 v[146:147], v[146:147], v[194:195], v[14:15]
  ds_read_b128 v[192:195], v5 offset:28672
  ds_read_b128 v[196:199], v5 offset:29696
  s_waitcnt lgkmcnt(2)
  v_pk_mul_f32 v[14:15], v[116:117], v[204:205]
  v_pk_mul_f32 v[116:117], v[116:117], v[200:201]
  v_pk_fma_f32 v[116:117], v[148:149], v[204:205], v[116:117] neg_lo:[1,0,0] neg_hi:[1,0,0]
  v_pk_fma_f32 v[148:149], v[148:149], v[200:201], v[14:15]
  v_pk_mul_f32 v[14:15], v[118:119], v[206:207]
  v_pk_mul_f32 v[118:119], v[118:119], v[202:203]
  v_pk_fma_f32 v[118:119], v[150:151], v[206:207], v[118:119] neg_lo:[1,0,0] neg_hi:[1,0,0]
  v_pk_fma_f32 v[150:151], v[150:151], v[202:203], v[14:15]
  ds_read_b128 v[200:203], v5 offset:30720
  ds_read_b128 v[204:207], v5 offset:31744
  s_waitcnt lgkmcnt(2)
  v_pk_mul_f32 v[14:15], v[120:121], v[196:197]
  v_pk_mul_f32 v[120:121], v[120:121], v[192:193]
  v_pk_fma_f32 v[120:121], v[152:153], v[196:197], v[120:121] neg_lo:[1,0,0] neg_hi:[1,0,0]
  v_pk_fma_f32 v[152:153], v[152:153], v[192:193], v[14:15]
  v_pk_mul_f32 v[14:15], v[122:123], v[198:199]
  v_pk_mul_f32 v[122:123], v[122:123], v[194:195]
  v_pk_fma_f32 v[122:123], v[154:155], v[198:199], v[122:123] neg_lo:[1,0,0] neg_hi:[1,0,0]
  v_pk_fma_f32 v[154:155], v[154:155], v[194:195], v[14:15]
  s_waitcnt lgkmcnt(0)
  v_pk_mul_f32 v[14:15], v[124:125], v[204:205]
  v_pk_mul_f32 v[124:125], v[124:125], v[200:201]
  v_pk_fma_f32 v[124:125], v[156:157], v[204:205], v[124:125] neg_lo:[1,0,0] neg_hi:[1,0,0]
  v_pk_fma_f32 v[156:157], v[156:157], v[200:201], v[14:15]
  v_pk_mul_f32 v[14:15], v[126:127], v[206:207]
  v_pk_mul_f32 v[126:127], v[126:127], v[202:203]
  v_pk_fma_f32 v[126:127], v[158:159], v[206:207], v[126:127] neg_lo:[1,0,0] neg_hi:[1,0,0]
  v_pk_fma_f32 v[158:159], v[158:159], v[202:203], v[14:15]
  v_cvt_pk_bf16_f32 v160, v96, v97
  v_cvt_pk_bf16_f32 v176, v128, v129
  v_cvt_pk_bf16_f32 v161, v98, v99
  v_cvt_pk_bf16_f32 v177, v130, v131
  v_cvt_pk_bf16_f32 v162, v100, v101
  v_cvt_pk_bf16_f32 v178, v132, v133
  v_cvt_pk_bf16_f32 v163, v102, v103
  v_cvt_pk_bf16_f32 v179, v134, v135
  v_cvt_pk_bf16_f32 v164, v104, v105
  v_cvt_pk_bf16_f32 v180, v136, v137
  v_cvt_pk_bf16_f32 v165, v106, v107
  v_cvt_pk_bf16_f32 v181, v138, v139
  v_cvt_pk_bf16_f32 v166, v108, v109
  v_cvt_pk_bf16_f32 v182, v140, v141
  v_cvt_pk_bf16_f32 v167, v110, v111
  v_cvt_pk_bf16_f32 v183, v142, v143
  v_cvt_pk_bf16_f32 v168, v112, v113
  v_cvt_pk_bf16_f32 v184, v144, v145
  v_cvt_pk_bf16_f32 v169, v114, v115
  v_cvt_pk_bf16_f32 v185, v146, v147
  v_cvt_pk_bf16_f32 v170, v116, v117
  v_cvt_pk_bf16_f32 v186, v148, v149
  v_cvt_pk_bf16_f32 v171, v118, v119
  v_cvt_pk_bf16_f32 v187, v150, v151
  v_cvt_pk_bf16_f32 v172, v120, v121
  v_cvt_pk_bf16_f32 v188, v152, v153
  v_cvt_pk_bf16_f32 v173, v122, v123
  v_cvt_pk_bf16_f32 v189, v154, v155
  v_cvt_pk_bf16_f32 v174, v124, v125
  v_cvt_pk_bf16_f32 v190, v156, v157
  v_cvt_pk_bf16_f32 v175, v126, v127
  v_cvt_pk_bf16_f32 v191, v158, v159
  v_mfma_f32_32x32x16_bf16 v[96:111], v[160:163], v[16:19], 0
  v_mfma_f32_32x32x16_bf16 v[128:143], v[176:179], v[16:19], 0
  v_mfma_f32_32x32x16_bf16 v[96:111], v[176:179], v[24:27], v[96:111]
  v_mfma_f32_32x32x16_bf16 v[128:143], v[160:163], v[32:35], v[128:143]
  v_mfma_f32_32x32x16_bf16 v[96:111], v[164:167], v[20:23], v[96:111]
  v_mfma_f32_32x32x16_bf16 v[128:143], v[180:183], v[20:23], v[128:143]
  v_mfma_f32_32x32x16_bf16 v[96:111], v[180:183], v[28:31], v[96:111]
  v_mfma_f32_32x32x16_bf16 v[128:143], v[164:167], v[36:39], v[128:143]
  v_mfma_f32_32x32x16_bf16 v[112:127], v[168:171], v[16:19], 0
  v_mfma_f32_32x32x16_bf16 v[144:159], v[184:187], v[16:19], 0
  v_mfma_f32_32x32x16_bf16 v[112:127], v[184:187], v[24:27], v[112:127]
  v_mfma_f32_32x32x16_bf16 v[144:159], v[168:171], v[32:35], v[144:159]
  v_mfma_f32_32x32x16_bf16 v[112:127], v[172:175], v[20:23], v[112:127]
  v_mfma_f32_32x32x16_bf16 v[144:159], v[188:191], v[20:23], v[144:159]
  v_mfma_f32_32x32x16_bf16 v[112:127], v[188:191], v[28:31], v[112:127]
  v_mfma_f32_32x32x16_bf16 v[144:159], v[172:175], v[36:39], v[144:159]
  s_cmp_eq_u32 s31, 3
  s_cbranch_scc1 cf_nyq
  s_barrier
  v_cvt_pk_bf16_f32 v160, v96, v97
  v_cvt_pk_bf16_f32 v161, v98, v99
  ds_write_b64 v9, v[160:161] offset:0
  v_cvt_pk_bf16_f32 v162, v100, v101
  v_cvt_pk_bf16_f32 v163, v102, v103
  ds_write_b64 v9, v[162:163] offset:512
  v_cvt_pk_bf16_f32 v164, v104, v105
  v_cvt_pk_bf16_f32 v165, v106, v107
  ds_write_b64 v9, v[164:165] offset:1024
  v_cvt_pk_bf16_f32 v166, v108, v109
  v_cvt_pk_bf16_f32 v167, v110, v111
  ds_write_b64 v9, v[166:167] offset:1536
  v_cvt_pk_bf16_f32 v168, v112, v113
  v_cvt_pk_bf16_f32 v169, v114, v115
  ds_write_b64 v9, v[168:169] offset:2048
  v_cvt_pk_bf16_f32 v170, v116, v117
  v_cvt_pk_bf16_f32 v171, v118, v119
  ds_write_b64 v9, v[170:171] offset:2560
  v_cvt_pk_bf16_f32 v172, v120, v121
  v_cvt_pk_bf16_f32 v173, v122, v123
  ds_write_b64 v9, v[172:173] offset:3072
  v_cvt_pk_bf16_f32 v174, v124, v125
  v_cvt_pk_bf16_f32 v175, v126, v127
  ds_write_b64 v9, v[174:175] offset:3584
  v_cvt_pk_bf16_f32 v176, v128, v129
  v_cvt_pk_bf16_f32 v177, v130, v131
  ds_write_b64 v9, v[176:177] offset:4096
  v_cvt_pk_bf16_f32 v178, v132, v133
  v_cvt_pk_bf16_f32 v179, v134, v135
  ds_write_b64 v9, v[178:179] offset:4608
  v_cvt_pk_bf16_f32 v180, v136, v137
  v_cvt_pk_bf16_f32 v181, v138, v139
  ds_write_b64 v9, v[180:181] offset:5120
  v_cvt_pk_bf16_f32 v182, v140, v141
  v_cvt_pk_bf16_f32 v183, v142, v143
  ds_write_b64 v9, v[182:183] offset:5632
  v_cvt_pk_bf16_f32 v184, v144, v145
  v_cvt_pk_bf16_f32 v185, v146, v147
  ds_write_b64 v9, v[184:185] offset:6144
  v_cvt_pk_bf16_f32 v186, v148, v149
  v_cvt_pk_bf16_f32 v187, v150, v151
  ds_write_b64 v9, v[186:187] offset:6656
  v_cvt_pk_bf16_f32 v188, v152, v153
  v_cvt_pk_bf16_f32 v189, v154, v155
  ds_write_b64 v9, v[188:189] offset:7168
  v_cvt_pk_bf16_f32 v190, v156, v157
  v_cvt_pk_bf16_f32 v191, v158, v159
  ds_write_b64 v9, v[190:191] offset:7680
  s_waitcnt lgkmcnt(0)
  s_barrier
  v_xor_b32 v14, 0, v10
  ds_read_b64_tr_b16 v[208:209], v14 offset:0
  ds_read_b64_tr_b16 v[210:211], v14 offset:32768
  v_xor_b32 v14, 64, v10
  ds_read_b64_tr_b16 v[212:213], v14 offset:0
  ds_read_b64_tr_b16 v[214:215], v14 offset:32768
  v_xor_b32 v14, 128, v10
  ds_read_b64_tr_b16 v[216:217], v14 offset:0
  ds_read_b64_tr_b16 v[218:219], v14 offset:32768
  v_xor_b32 v14, 192, v10
  ds_read_b64_tr_b16 v[220:221], v14 offset:0
  ds_read_b64_tr_b16 v[222:223], v14 offset:32768
  v_xor_b32 v14, 0, v10
  ds_read_b64_tr_b16 v[224:225], v14 offset:256
  ds_read_b64_tr_b16 v[226:227], v14 offset:33024
  v_xor_b32 v14, 64, v10
  ds_read_b64_tr_b16 v[228:229], v14 offset:256
  ds_read_b64_tr_b16 v[230:231], v14 offset:33024
  v_xor_b32 v14, 128, v10
  ds_read_b64_tr_b16 v[232:233], v14 offset:256
  ds_read_b64_tr_b16 v[234:235], v14 offset:33024
  v_xor_b32 v14, 192, v10
  ds_read_b64_tr_b16 v[236:237], v14 offset:256
  ds_read_b64_tr_b16 v[238:239], v14 offset:33024
  s_add_u32 s28, s44, 0
  s_waitcnt lgkmcnt(14)
  buffer_store_dwordx4 v[208:211], v11, s[32:35], s28 offen sc1
  s_add_u32 s28, s44, 16384
  s_waitcnt lgkmcnt(12)
  buffer_store_dwordx4 v[212:215], v11, s[32:35], s28 offen sc1
  s_add_u32 s28, s44, 32768
  s_waitcnt lgkmcnt(10)
  buffer_store_dwordx4 v[216:219], v11, s[32:35], s28 offen sc1
  s_add_u32 s28, s44, 49152
  s_waitcnt lgkmcnt(8)
  buffer_store_dwordx4 v[220:223], v11, s[32:35], s28 offen sc1
  s_add_u32 s28, s44, 128
  s_waitcnt lgkmcnt(6)
  buffer_store_dwordx4 v[224:227], v11, s[32:35], s28 offen sc1
  s_add_u32 s28, s44, 16512
  s_waitcnt lgkmcnt(4)
  buffer_store_dwordx4 v[228:231], v11, s[32:35], s28 offen sc1
  s_add_u32 s28, s44, 32896
  s_waitcnt lgkmcnt(2)
  buffer_store_dwordx4 v[232:235], v11, s[32:35], s28 offen sc1
  s_add_u32 s28, s44, 49280
  s_waitcnt lgkmcnt(0)
  buffer_store_dwordx4 v[236:239], v11, s[32:35], s28 offen sc1
  s_add_u32 s44, s44, 0x10000
  s_waitcnt vmcnt(10)
  s_cmp_lt_u32 s31, s30
  s_cbranch_scc1 cf_loop
  s_branch cf_done
cf_nyq:
  v_lshlrev_b32 v14, 8, v12
  v_lshl_add_u32 v14, v13, 4, v14
  s_nop 12
  buffer_store_dwordx4 v[96:99], v14, s[40:43], 0 offen offset:0 sc1
  buffer_store_dwordx4 v[100:103], v14, s[40:43], 0 offen offset:32 sc1
  buffer_store_dwordx4 v[104:107], v14, s[40:43], 0 offen offset:64 sc1
  buffer_store_dwordx4 v[108:111], v14, s[40:43], 0 offen offset:96 sc1
  buffer_store_dwordx4 v[112:115], v14, s[40:43], 0 offen offset:128 sc1
  buffer_store_dwordx4 v[116:119], v14, s[40:43], 0 offen offset:160 sc1
  buffer_store_dwordx4 v[120:123], v14, s[40:43], 0 offen offset:192 sc1
  buffer_store_dwordx4 v[124:127], v14, s[40:43], 0 offen offset:224 sc1
cf_done:
  s_setprio 0
  s_waitcnt vmcnt(0)
  s_barrier
  s_lshl_b32 s87, s21, 2
  s_add_u32 s87, s87, 65536
  s_mov_b32 s86, 1
  s_cmp_lg_u32 s20, 0
  s_cbranch_scc1 rp_s
  v_mov_b32 v14, s88
  v_lshlrev_b32 v15, 7, v2
  s_mov_b32 exec_lo, -1
  s_mov_b32 exec_hi, 0
  buffer_store_dword v14, v15, s[92:95], s87 offen sc1
  s_mov_b64 exec, -1
rp_s:
k2_in:
  s_setprio 0
  s_load_dwordx2 s[4:5], s[0:1], 0
  s_load_dwordx4 s[36:39], s[0:1], 48
  s_load_dwordx2 s[6:7], s[0:1], 72
  s_and_b32 s3, s2, 7
  s_lshr_b32 s23, s2, 3
  s_lshr_b32 s21, s3, 1
  s_lshl_b32 s21, s21, 2
  s_and_b32 s24, s23, 3
  s_add_u32 s21, s21, s24
  s_and_b32 s22, s3, 1
  s_lshl_b32 s22, s22, 3
  s_lshr_b32 s24, s23, 2
  s_add_u32 s22, s22, s24
  s_cmp_lt_u32 s20, 4
  s_cbranch_scc1 k2_go
  s_waitcnt lgkmcnt(0)
  v_and_b32 v4, 31, v2
  v_lshrrev_b32 v5, 5, v2
  v_cvt_f32_u32 v4, v4
  v_cvt_f32_u32 v5, v5
  v_mul_f32 v5, 4.0, v5
  v_mul_f32 v6, 0xbd000000, v4
  v_mul_f32 v7, v5, v6
  v_fmamk_f32 v8, v6, 0x0, v7
  v_fmamk_f32 v9, v6, 0x3f800000, v7
  v_cos_f32 v10, v8
  v_cos_f32 v11, v9
  v_sin_f32 v8, v8
  v_sin_f32 v9, v9
  v_cvt_pk_bf16_f32 v28, v10, v11
  v_cvt_pk_bf16_f32 v36, v8, v9
  v_fmamk_f32 v8, v6, 0x40000000, v7
  v_fmamk_f32 v9, v6, 0x40400000, v7
  v_cos_f32 v10, v8
  v_cos_f32 v11, v9
  v_sin_f32 v8, v8
  v_sin_f32 v9, v9
  v_cvt_pk_bf16_f32 v29, v10, v11
  v_cvt_pk_bf16_f32 v37, v8, v9
  v_fmamk_f32 v8, v6, 0x41000000, v7
  v_fmamk_f32 v9, v6, 0x41100000, v7
  v_cos_f32 v10, v8
  v_cos_f32 v11, v9
  v_sin_f32 v8, v8
  v_sin_f32 v9, v9
  v_cvt_pk_bf16_f32 v30, v10, v11
  v_cvt_pk_bf16_f32 v38, v8, v9
  v_fmamk_f32 v8, v6, 0x41200000, v7
  v_fmamk_f32 v9, v6, 0x41300000, v7
  v_cos_f32 v10, v8
  v_cos_f32 v11, v9
  v_sin_f32 v8, v8
  v_sin_f32 v9, v9
  v_cvt_pk_bf16_f32 v31, v10, v11
  v_cvt_pk_bf16_f32 v39, v8, v9
  v_fmamk_f32 v8, v6, 0x41800000, v7
  v_fmamk_f32 v9, v6, 0x41880000, v7
  v_cos_f32 v10, v8
  v_cos_f32 v11, v9
  v_sin_f32 v8, v8
  v_sin_f32 v9, v9
  v_cvt_pk_bf16_f32 v32, v10, v11
  v_cvt_pk_bf16_f32 v40, v8, v9
  v_fmamk_f32 v8, v6, 0x41900000, v7
  v_fmamk_f32 v9, v6, 0x41980000, v7
  v_cos_f32 v10, v8
  v_cos_f32 v11, v9
  v_sin_f32 v8, v8
  v_sin_f32 v9, v9
  v_cvt_pk_bf16_f32 v33, v10, v11
  v_cvt_pk_bf16_f32 v41, v8, v9
  v_fmamk_f32 v8, v6, 0x41c00000, v7
  v_fmamk_f32 v9, v6, 0x41c80000, v7
  v_cos_f32 v10, v8
  v_cos_f32 v11, v9
  v_sin_f32 v8, v8
  v_sin_f32 v9, v9
  v_cvt_pk_bf16_f32 v34, v10, v11
  v_cvt_pk_bf16_f32 v42, v8, v9
  v_fmamk_f32 v8, v6, 0x41d00000, v7
  v_fmamk_f32 v9, v6, 0x41d80000, v7
  v_cos_f32 v10, v8
  v_cos_f32 v11, v9
  v_sin_f32 v8, v8
  v_sin_f32 v9, v9
  v_cvt_pk_bf16_f32 v35, v10, v11
  v_cvt_pk_bf16_f32 v43, v8, v9
  v_xor_b32 v20, 0x80008000, v36
  v_xor_b32 v21, 0x80008000, v37
  v_xor_b32 v22, 0x80008000, v38
  v_xor_b32 v23, 0x80008000, v39
  v_mul_f32 v6, 0x3a800000, v4
  v_mul_f32 v7, v5, v6
  v_fmamk_f32 v8, v6, 0x0, v7
  v_fmamk_f32 v9, v6, 0x3f800000, v7
  v_cos_f32 v44, v8
  v_sin_f32 v60, v8
  v_cos_f32 v45, v9
  v_sin_f32 v61, v9
  v_fmamk_f32 v8, v6, 0x40000000, v7
  v_fmamk_f32 v9, v6, 0x40400000, v7
  v_cos_f32 v46, v8
  v_sin_f32 v62, v8
  v_cos_f32 v47, v9
  v_sin_f32 v63, v9
  v_fmamk_f32 v8, v6, 0x41000000, v7
  v_fmamk_f32 v9, v6, 0x41100000, v7
  v_cos_f32 v48, v8
  v_sin_f32 v64, v8
  v_cos_f32 v49, v9
  v_sin_f32 v65, v9
  v_fmamk_f32 v8, v6, 0x41200000, v7
  v_fmamk_f32 v9, v6, 0x41300000, v7
  v_cos_f32 v50, v8
  v_sin_f32 v66, v8
  v_cos_f32 v51, v9
  v_sin_f32 v67, v9
  v_fmamk_f32 v8, v6, 0x41800000, v7
  v_fmamk_f32 v9, v6, 0x41880000, v7
  v_cos_f32 v52, v8
  v_sin_f32 v68, v8
  v_cos_f32 v53, v9
  v_sin_f32 v69, v9
  v_fmamk_f32 v8, v6, 0x41900000, v7
  v_fmamk_f32 v9, v6, 0x41980000, v7
  v_cos_f32 v54, v8
  v_sin_f32 v70, v8
  v_cos_f32 v55, v9
  v_sin_f32 v71, v9
  v_fmamk_f32 v8, v6, 0x41c00000, v7
  v_fmamk_f32 v9, v6, 0x41c80000, v7
  v_cos_f32 v56, v8
  v_sin_f32 v72, v8
  v_cos_f32 v57, v9
  v_sin_f32 v73, v9
  v_fmamk_f32 v8, v6, 0x41d00000, v7
  v_fmamk_f32 v9, v6, 0x41d80000, v7
  v_cos_f32 v58, v8
  v_sin_f32 v74, v8
  v_cos_f32 v59, v9
  v_sin_f32 v75, v9
  s_add_u32 s12, s90, 0x1c00000
  s_addc_u32 s13, s91, 0
  s_mov_b32 s14, 0x400000
  s_mov_b32 s15, 0x20000
  s_add_u32 s32, s90, 0x1800000
  s_addc_u32 s33, s91, 0
  s_mov_b32 s34, 0x400000
  s_mov_b32 s35, 0x20000
  s_add_u32 s40, s90, 0x2000000
  s_addc_u32 s41, s91, 0
  s_mov_b32 s42, 0x2000
  s_mov_b32 s43, 0x20000
  v_lshrrev_b32 v4, 4, v2
  v_xor_b32 v3, v4, v2
  v_and_b32 v3, 7, v3
  v_lshlrev_b32 v3, 4, v3
  v_lshrrev_b32 v4, 3, v2
  v_lshl_add_u32 v3, v4, 16, v3
  v_xor_b32 v13, 64, v3
  s_lshl_b32 s21, s21, 4
  s_add_u32 s21, s21, s22
  s_lshl_b32 s21, s21, 2
  s_add_u32 s21, s21, s20
  s_sub_u32 s21, s21, 4
  s_lshl_b32 s87, s21, 2
  s_add_u32 s87, s87, 36864
  s_lshr_b32 s22, s21, 1
  s_lshl_b32 s22, s22, 7
  s_lshl_b32 s23, s21, 3
  s_lshl_b32 s21, s21, 12
  s_lshl_b32 s29, s20, 13
  s_add_u32 s29, s29, 0x18000
  s_and_b32 s24, s2, 31
  s_lshl_b32 s24, s24, 7
  s_add_u32 s24, s24, 65536
  s_mov_b32 s26, -1
  s_mov_b32 s27, 0
  s_and_b32 s28, s20, 1
  s_lshl_b32 s28, s28, 5
  v_bfe_u32 v4, v2, 2, 2
  v_bfe_u32 v5, v2, 4, 1
  v_lshl_add_u32 v4, v4, 1, v5
  v_mul_u32_u24 v4, 0x110, v4
  v_bfe_u32 v6, v2, 1, 1
  v_lshl_add_u32 v4, v6, 7, v4
  v_lshrrev_b32 v7, 5, v2
  v_lshl_add_u32 v4, v7, 11, v4
  v_and_b32 v12, 1, v2
  v_lshl_add_u32 v4, v12, 3, v4
  v_add_u32 v4, s29, v4
  v_and_b32 v6, 15, v2
  v_lshlrev_b32 v6, 6, v6
  v_lshl_add_u32 v6, v5, 5, v6
  v_lshl_add_u32 v6, v7, 4, v6
  v_lshlrev_b32 v7, 2, v12
  v_xor_b32 v8, s28, v4
  v_xor_b32 v9, 64, v8
  v_xor_b32 v10, 16, v8
  v_xor_b32 v11, 0x50, v8
  v_lshlrev_b32 v15, 2, v2
  s_mov_b64 exec, s[26:27]
  buffer_load_dword v14, v15, s[92:95], s24 offen sc1
  s_waitcnt vmcnt(0)
  s_barrier
  v_cmp_ne_u32 vcc, s88, v14
  s_nop 4
  s_cbranch_vccz rp_p_ok
  v_lshlrev_b32 v15, 2, v2
  s_mov_b64 exec, s[26:27]
rp_p:
  buffer_load_dword v14, v15, s[92:95], s24 offen sc1
  s_waitcnt vmcnt(0)
  v_cmp_ne_u32 vcc, s88, v14
  s_nop 4
  s_cbranch_vccnz rp_p
rp_p_ok:
  s_mov_b64 exec, -1
  s_add_u32 m0, s29, 0
  s_nop 0
  buffer_load_dwordx4 v3, s[32:35], s22 offen sc1 lds
  s_add_u32 s22, s22, 0x80000
  s_add_u32 m0, s29, 1024
  s_nop 0
  buffer_load_dwordx4 v13, s[32:35], s22 offen sc1 lds
  s_add_u32 s22, s22, 0x80000
  s_add_u32 m0, s29, 2048
  s_nop 0
  buffer_load_dwordx4 v3, s[32:35], s22 offen sc1 lds
  s_add_u32 s22, s22, 0x80000
  s_add_u32 m0, s29, 3072
  s_nop 0
  buffer_load_dwordx4 v13, s[32:35], s22 offen sc1 lds
  s_add_u32 s22, s22, 0x80000
  s_add_u32 m0, s29, 4096
  s_nop 0
  buffer_load_dwordx4 v3, s[32:35], s22 offen sc1 lds
  s_add_u32 s22, s22, 0x80000
  s_add_u32 m0, s29, 5120
  s_nop 0
  buffer_load_dwordx4 v13, s[32:35], s22 offen sc1 lds
  s_add_u32 s22, s22, 0x80000
  s_add_u32 m0, s29, 6144
  s_nop 0
  buffer_load_dwordx4 v3, s[32:35], s22 offen sc1 lds
  s_add_u32 s22, s22, 0x80000
  s_add_u32 m0, s29, 7168
  s_nop 0
  buffer_load_dwordx4 v13, s[32:35], s22 offen sc1 lds
  s_add_u32 s22, s22, 0x80000
  buffer_load_dword v7, v7, s[40:43], s23 offen sc1
  s_barrier
  s_barrier
  s_waitcnt vmcnt(0)
  v_readlane_b32 s24, v7, 0
  v_readlane_b32 s25, v7, 1
  ds_read_b64_tr_b16 v[108:109], v8 offset:0
  ds_read_b64_tr_b16 v[112:113], v9 offset:0
  ds_read_b64_tr_b16 v[110:111], v8 offset:4096
  ds_read_b64_tr_b16 v[114:115], v9 offset:4096
  ds_read_b64_tr_b16 v[156:157], v10 offset:0
  ds_read_b64_tr_b16 v[160:161], v11 offset:0
  ds_read_b64_tr_b16 v[158:159], v10 offset:4096
  ds_read_b64_tr_b16 v[162:163], v11 offset:4096
  s_waitcnt lgkmcnt(4)
  v_mfma_f32_32x32x16_bf16 v[76:91], v[108:111], v[28:31], 0
  v_mfma_f32_32x32x16_bf16 v[92:107], v[108:111], v[20:23], 0
  v_mfma_f32_32x32x16_bf16 v[76:91], v[112:115], v[36:39], v[76:91]
  v_mfma_f32_32x32x16_bf16 v[92:107], v[112:115], v[28:31], v[92:107]
  s_waitcnt lgkmcnt(0)
  v_mfma_f32_32x32x16_bf16 v[124:139], v[156:159], v[28:31], 0
  v_mfma_f32_32x32x16_bf16 v[140:155], v[156:159], v[20:23], 0
  v_mfma_f32_32x32x16_bf16 v[124:139], v[160:163], v[36:39], v[124:139]
  v_mfma_f32_32x32x16_bf16 v[140:155], v[160:163], v[28:31], v[140:155]
  s_nop 5
  v_pk_mul_f32 v[172:173], v[76:77], v[60:61]
  v_pk_mul_f32 v[76:77], v[76:77], v[44:45]
  v_pk_fma_f32 v[76:77], v[92:93], v[60:61], v[76:77] neg_lo:[1,0,0] neg_hi:[1,0,0]
  v_pk_fma_f32 v[92:93], v[92:93], v[44:45], v[172:173]
  v_pk_mul_f32 v[172:173], v[78:79], v[62:63]
  v_pk_mul_f32 v[78:79], v[78:79], v[46:47]
  v_pk_fma_f32 v[78:79], v[94:95], v[62:63], v[78:79] neg_lo:[1,0,0] neg_hi:[1,0,0]
  v_pk_fma_f32 v[94:95], v[94:95], v[46:47], v[172:173]
  v_pk_mul_f32 v[172:173], v[80:81], v[64:65]
  v_pk_mul_f32 v[80:81], v[80:81], v[48:49]
  v_pk_fma_f32 v[80:81], v[96:97], v[64:65], v[80:81] neg_lo:[1,0,0] neg_hi:[1,0,0]
  v_pk_fma_f32 v[96:97], v[96:97], v[48:49], v[172:173]
  v_pk_mul_f32 v[172:173], v[82:83], v[66:67]
  v_pk_mul_f32 v[82:83], v[82:83], v[50:51]
  v_pk_fma_f32 v[82:83], v[98:99], v[66:67], v[82:83] neg_lo:[1,0,0] neg_hi:[1,0,0]
  v_pk_fma_f32 v[98:99], v[98:99], v[50:51], v[172:173]
  v_pk_mul_f32 v[172:173], v[84:85], v[68:69]
  v_pk_mul_f32 v[84:85], v[84:85], v[52:53]
  v_pk_fma_f32 v[84:85], v[100:101], v[68:69], v[84:85] neg_lo:[1,0,0] neg_hi:[1,0,0]
  v_pk_fma_f32 v[100:101], v[100:101], v[52:53], v[172:173]
  v_pk_mul_f32 v[172:173], v[86:87], v[70:71]
  v_pk_mul_f32 v[86:87], v[86:87], v[54:55]
  v_pk_fma_f32 v[86:87], v[102:103], v[70:71], v[86:87] neg_lo:[1,0,0] neg_hi:[1,0,0]
  v_pk_fma_f32 v[102:103], v[102:103], v[54:55], v[172:173]
  v_pk_mul_f32 v[172:173], v[88:89], v[72:73]
  v_pk_mul_f32 v[88:89], v[88:89], v[56:57]
  v_pk_fma_f32 v[88:89], v[104:105], v[72:73], v[88:89] neg_lo:[1,0,0] neg_hi:[1,0,0]
  v_pk_fma_f32 v[104:105], v[104:105], v[56:57], v[172:173]
  v_pk_mul_f32 v[172:173], v[90:91], v[74:75]
  v_pk_mul_f32 v[90:91], v[90:91], v[58:59]
  v_pk_fma_f32 v[90:91], v[106:107], v[74:75], v[90:91] neg_lo:[1,0,0] neg_hi:[1,0,0]
  v_pk_fma_f32 v[106:107], v[106:107], v[58:59], v[172:173]
  v_cvt_pk_bf16_f32 v108, v76, v77
  v_cvt_pk_bf16_f32 v116, v92, v93
  v_cvt_pk_bf16_f32 v109, v78, v79
  v_cvt_pk_bf16_f32 v117, v94, v95
  v_cvt_pk_bf16_f32 v110, v80, v81
  v_cvt_pk_bf16_f32 v118, v96, v97
  v_cvt_pk_bf16_f32 v111, v82, v83
  v_cvt_pk_bf16_f32 v119, v98, v99
  v_cvt_pk_bf16_f32 v112, v84, v85
  v_cvt_pk_bf16_f32 v120, v100, v101
  v_cvt_pk_bf16_f32 v113, v86, v87
  v_cvt_pk_bf16_f32 v121, v102, v103
  v_cvt_pk_bf16_f32 v114, v88, v89
  v_cvt_pk_bf16_f32 v122, v104, v105
  v_cvt_pk_bf16_f32 v115, v90, v91
  v_cvt_pk_bf16_f32 v123, v106, v107
  v_mfma_f32_32x32x16_bf16 v[76:91], v[108:111], v[28:31], 0
  v_mfma_f32_32x32x16_bf16 v[76:91], v[112:115], v[32:35], v[76:91]
  v_mfma_f32_32x32x16_bf16 v[76:91], v[116:119], v[36:39], v[76:91]
  v_mfma_f32_32x32x16_bf16 v[76:91], v[120:123], v[40:43], v[76:91]
  s_barrier
  v_pk_mul_f32 v[172:173], v[124:125], v[60:61]
  v_pk_mul_f32 v[124:125], v[124:125], v[44:45]
  v_pk_fma_f32 v[124:125], v[140:141], v[60:61], v[124:125] neg_lo:[1,0,0] neg_hi:[1,0,0]
  v_pk_fma_f32 v[140:141], v[140:141], v[44:45], v[172:173]
  v_pk_mul_f32 v[172:173], v[126:127], v[62:63]
  v_pk_mul_f32 v[126:127], v[126:127], v[46:47]
  v_pk_fma_f32 v[126:127], v[142:143], v[62:63], v[126:127] neg_lo:[1,0,0] neg_hi:[1,0,0]
  v_pk_fma_f32 v[142:143], v[142:143], v[46:47], v[172:173]
  v_pk_mul_f32 v[172:173], v[128:129], v[64:65]
  v_pk_mul_f32 v[128:129], v[128:129], v[48:49]
  v_pk_fma_f32 v[128:129], v[144:145], v[64:65], v[128:129] neg_lo:[1,0,0] neg_hi:[1,0,0]
  v_pk_fma_f32 v[144:145], v[144:145], v[48:49], v[172:173]
  v_pk_mul_f32 v[172:173], v[130:131], v[66:67]
  v_pk_mul_f32 v[130:131], v[130:131], v[50:51]
  v_pk_fma_f32 v[130:131], v[146:147], v[66:67], v[130:131] neg_lo:[1,0,0] neg_hi:[1,0,0]
  v_pk_fma_f32 v[146:147], v[146:147], v[50:51], v[172:173]
  v_pk_mul_f32 v[172:173], v[132:133], v[68:69]
  v_pk_mul_f32 v[132:133], v[132:133], v[52:53]
  v_pk_fma_f32 v[132:133], v[148:149], v[68:69], v[132:133] neg_lo:[1,0,0] neg_hi:[1,0,0]
  v_pk_fma_f32 v[148:149], v[148:149], v[52:53], v[172:173]
  v_pk_mul_f32 v[172:173], v[134:135], v[70:71]
  v_pk_mul_f32 v[134:135], v[134:135], v[54:55]
  v_pk_fma_f32 v[134:135], v[150:151], v[70:71], v[134:135] neg_lo:[1,0,0] neg_hi:[1,0,0]
  v_pk_fma_f32 v[150:151], v[150:151], v[54:55], v[172:173]
  v_pk_mul_f32 v[172:173], v[136:137], v[72:73]
  v_pk_mul_f32 v[136:137], v[136:137], v[56:57]
  v_pk_fma_f32 v[136:137], v[152:153], v[72:73], v[136:137] neg_lo:[1,0,0] neg_hi:[1,0,0]
  v_pk_fma_f32 v[152:153], v[152:153], v[56:57], v[172:173]
  v_pk_mul_f32 v[172:173], v[138:139], v[74:75]
  v_pk_mul_f32 v[138:139], v[138:139], v[58:59]
  v_pk_fma_f32 v[138:139], v[154:155], v[74:75], v[138:139] neg_lo:[1,0,0] neg_hi:[1,0,0]
  v_pk_fma_f32 v[154:155], v[154:155], v[58:59], v[172:173]
  v_cvt_pk_bf16_f32 v156, v124, v125
  v_cvt_pk_bf16_f32 v164, v140, v141
  v_cvt_pk_bf16_f32 v157, v126, v127
  v_cvt_pk_bf16_f32 v165, v142, v143
  v_cvt_pk_bf16_f32 v158, v128, v129
  v_cvt_pk_bf16_f32 v166, v144, v145
  v_cvt_pk_bf16_f32 v159, v130, v131
  v_cvt_pk_bf16_f32 v167, v146, v147
  v_cvt_pk_bf16_f32 v160, v132, v133
  v_cvt_pk_bf16_f32 v168, v148, v149
  v_cvt_pk_bf16_f32 v161, v134, v135
  v_cvt_pk_bf16_f32 v169, v150, v151
  v_cvt_pk_bf16_f32 v162, v136, v137
  v_cvt_pk_bf16_f32 v170, v152, v153
  v_cvt_pk_bf16_f32 v163, v138, v139
  v_cvt_pk_bf16_f32 v171, v154, v155
  v_mfma_f32_32x32x16_bf16 v[124:139], v[156:159], v[28:31], 0
  v_mfma_f32_32x32x16_bf16 v[124:139], v[160:163], v[32:35], v[124:139]
  v_mfma_f32_32x32x16_bf16 v[124:139], v[164:167], v[36:39], v[124:139]
  v_mfma_f32_32x32x16_bf16 v[124:139], v[168:171], v[40:43], v[124:139]
  s_barrier
  v_add_f32 v76, s24, v76
  v_subrev_f32 v77, s24, v77
  v_cvt_pk_bf16_f32 v92, v76, v77
  v_add_f32 v78, s24, v78
  v_subrev_f32 v79, s24, v79
  v_cvt_pk_bf16_f32 v93, v78, v79
  v_add_f32 v80, s24, v80
  v_subrev_f32 v81, s24, v81
  v_cvt_pk_bf16_f32 v94, v80, v81
  v_add_f32 v82, s24, v82
  v_subrev_f32 v83, s24, v83
  v_cvt_pk_bf16_f32 v95, v82, v83
  v_add_f32 v84, s24, v84
  v_subrev_f32 v85, s24, v85
  v_cvt_pk_bf16_f32 v96, v84, v85
  v_add_f32 v86, s24, v86
  v_subrev_f32 v87, s24, v87
  v_cvt_pk_bf16_f32 v97, v86, v87
  v_add_f32 v88, s24, v88
  v_subrev_f32 v89, s24, v89
  v_cvt_pk_bf16_f32 v98, v88, v89
  v_add_f32 v90, s24, v90
  v_subrev_f32 v91, s24, v91
  v_cvt_pk_bf16_f32 v99, v90, v91
  v_permlane32_swap_b32 v92, v94
  v_permlane32_swap_b32 v93, v95
  v_permlane32_swap_b32 v96, v98
  v_permlane32_swap_b32 v97, v99
  s_nop 0
  v_permlane16_swap_b32 v92, v96
  v_permlane16_swap_b32 v93, v97
  v_permlane16_swap_b32 v94, v98
  v_permlane16_swap_b32 v95, v99
  buffer_store_dwordx4 v[92:95], v6, s[12:15], s21 offen offset:0 sc1
  buffer_store_dwordx4 v[96:99], v6, s[12:15], s21 offen offset:1024 sc1
  v_add_f32 v124, s25, v124
  v_subrev_f32 v125, s25, v125
  v_cvt_pk_bf16_f32 v140, v124, v125
  v_add_f32 v126, s25, v126
  v_subrev_f32 v127, s25, v127
  v_cvt_pk_bf16_f32 v141, v126, v127
  v_add_f32 v128, s25, v128
  v_subrev_f32 v129, s25, v129
  v_cvt_pk_bf16_f32 v142, v128, v129
  v_add_f32 v130, s25, v130
  v_subrev_f32 v131, s25, v131
  v_cvt_pk_bf16_f32 v143, v130, v131
  v_add_f32 v132, s25, v132
  v_subrev_f32 v133, s25, v133
  v_cvt_pk_bf16_f32 v144, v132, v133
  v_add_f32 v134, s25, v134
  v_subrev_f32 v135, s25, v135
  v_cvt_pk_bf16_f32 v145, v134, v135
  v_add_f32 v136, s25, v136
  v_subrev_f32 v137, s25, v137
  v_cvt_pk_bf16_f32 v146, v136, v137
  v_add_f32 v138, s25, v138
  v_subrev_f32 v139, s25, v139
  v_cvt_pk_bf16_f32 v147, v138, v139
  v_permlane32_swap_b32 v140, v142
  v_permlane32_swap_b32 v141, v143
  v_permlane32_swap_b32 v144, v146
  v_permlane32_swap_b32 v145, v147
  s_nop 0
  v_permlane16_swap_b32 v140, v144
  v_permlane16_swap_b32 v141, v145
  v_permlane16_swap_b32 v142, v146
  v_permlane16_swap_b32 v143, v147
  buffer_store_dwordx4 v[140:143], v6, s[12:15], s21 offen offset:2048 sc1
  buffer_store_dwordx4 v[144:147], v6, s[12:15], s21 offen offset:3072 sc1
  s_barrier
  s_barrier
  s_waitcnt vmcnt(0)
  s_cmp_lg_u32 s20, s20
  s_cbranch_scc1 rp_e
  v_mov_b32 v14, s88
  v_lshlrev_b32 v15, 7, v2
  s_mov_b32 exec_lo, 1
  s_mov_b32 exec_hi, 0
  buffer_store_dword v14, v15, s[92:95], s87 offen sc1
  s_mov_b64 exec, -1
rp_e:
  s_endpgm
k2_go:
  s_and_b32 s23, s20, 3
  s_lshr_b32 s24, s20, 2
  s_lshl_b32 s26, s21, 3
  s_mul_i32 s25, s23, 2
  s_add_u32 s26, s26, s25
  s_mul_i32 s26, s26, 112
  s_mul_i32 s25, s24, 112
  s_add_u32 s26, s26, s25
  s_lshl_b32 s26, s26, 10
  s_mul_i32 s28, s24, 3584
  s_lshl_b32 s25, s23, 5
  s_add_u32 s28, s28, s25
  s_lshl_b32 s28, s28, 11
  s_lshl_b32 s25, s22, 7
  s_add_u32 s28, s28, s25
  s_lshl_b32 s29, s20, 12
  v_lshlrev_b32 v3, 4, v2
  v_lshrrev_b32 v4, 3, v2
  v_lshlrev_b32 v4, 11, v4
  v_lshrrev_b32 v5, 4, v2
  v_lshlrev_b32 v6, 1, v5
  v_xor_b32 v6, v6, v2
  v_and_b32 v6, 7, v6
  v_lshl_add_u32 v4, v6, 4, v4
  v_add_u32 v5, 16384, v4
  v_add_u32 v6, 32768, v4
  v_add_u32 v7, 49152, v4
  v_add_u32 v20, 114688, v3
  s_waitcnt lgkmcnt(0)
  s_add_u32 s8, s6, 0x800000
  s_addc_u32 s9, s7, 0
  s_mov_b32 s10, 0xe00000
  s_mov_b32 s11, 0x20000
  s_mov_b32 s12, s36
  s_mov_b32 s13, s37
  s_mov_b32 s14, 0x700000
  s_mov_b32 s15, 0x20000
  s_mov_b32 s16, s4
  s_mov_b32 s17, s5
  s_mov_b32 s18, 0x400000
  s_mov_b32 s19, 0x20000
  s_add_u32 s32, s6, 0x1c00000
  s_addc_u32 s33, s7, 0
  s_mov_b32 s34, 0x400000
  s_mov_b32 s35, 0x20000
  s_mov_b32 s40, s38
  s_mov_b32 s41, s39
  s_mov_b32 s42, 0x400000
  s_mov_b32 s43, 0x20000
  s_add_u32 m0, s29, 0
  s_nop 0
  buffer_load_dwordx4 v4, s[12:15], s28 offen lds
  s_add_u32 m0, s29, 1024
  s_nop 0
  buffer_load_dwordx4 v5, s[12:15], s28 offen lds
  s_add_u32 m0, s29, 2048
  s_nop 0
  buffer_load_dwordx4 v6, s[12:15], s28 offen lds
  s_add_u32 m0, s29, 3072
  s_nop 0
  buffer_load_dwordx4 v7, s[12:15], s28 offen lds
  s_add_u32 s28, s28, 262144
  s_add_u32 m0, s29, 16384
  s_nop 0
  buffer_load_dwordx4 v4, s[12:15], s28 offen lds
  s_add_u32 m0, s29, 17408
  s_nop 0
  buffer_load_dwordx4 v5, s[12:15], s28 offen lds
  s_add_u32 m0, s29, 18432
  s_nop 0
  buffer_load_dwordx4 v6, s[12:15], s28 offen lds
  s_add_u32 m0, s29, 19456
  s_nop 0
  buffer_load_dwordx4 v7, s[12:15], s28 offen lds
  s_add_u32 s28, s28, 262144
  s_add_u32 m0, s29, 32768
  s_nop 0
  buffer_load_dwordx4 v4, s[12:15], s28 offen lds
  s_add_u32 m0, s29, 33792
  s_nop 0
  buffer_load_dwordx4 v5, s[12:15], s28 offen lds
  s_add_u32 m0, s29, 34816
  s_nop 0
  buffer_load_dwordx4 v6, s[12:15], s28 offen lds
  s_add_u32 m0, s29, 35840
  s_nop 0
  buffer_load_dwordx4 v7, s[12:15], s28 offen lds
  s_add_u32 s28, s28, 262144
  v_lshrrev_b32 v12, 2, v2
  v_lshlrev_b32 v8, 7, v12
  v_bfe_u32 v12, v2, 3, 2
  v_lshl_add_u32 v8, v12, 5, v8
  v_and_b32 v12, 3, v2
  v_lshl_add_u32 v8, v12, 3, v8
  s_lshl_b32 s25, s24, 14
  v_add_u32 v8, s25, v8
  v_xor_b32 v9, 32, v8
  v_xor_b32 v10, 64, v8
  v_xor_b32 v11, 96, v8
  v_mov_b32 v224, 0
  v_mov_b32 v225, 0
  v_mov_b32 v226, 0
  v_mov_b32 v227, 0
  v_mov_b32 v228, 0
  v_mov_b32 v229, 0
  v_mov_b32 v230, 0
  v_mov_b32 v231, 0
  v_mov_b32 v232, 0
  v_mov_b32 v233, 0
  v_mov_b32 v234, 0
  v_mov_b32 v235, 0
  v_mov_b32 v236, 0
  v_mov_b32 v237, 0
  v_mov_b32 v238, 0
  v_mov_b32 v239, 0
  v_mov_b32 v240, 0
  v_mov_b32 v241, 0
  v_mov_b32 v242, 0
  v_mov_b32 v243, 0
  v_mov_b32 v244, 0
  v_mov_b32 v245, 0
  v_mov_b32 v246, 0
  v_mov_b32 v247, 0
  v_mov_b32 v248, 0
  v_mov_b32 v249, 0
  v_mov_b32 v250, 0
  v_mov_b32 v251, 0
  v_mov_b32 v252, 0
  v_mov_b32 v253, 0
  v_mov_b32 v254, 0
  v_mov_b32 v255, 0
  v_and_b32 v12, 15, v2
  v_lshlrev_b32 v12, 11, v12
  v_bfe_u32 v13, v2, 4, 1
  v_lshl_add_u32 v12, v13, 5, v12
  v_lshrrev_b32 v13, 5, v2
  v_lshl_add_u32 v12, v13, 4, v12
  v_add_u32 v13, 0x8000, v12
  s_mul_i32 s25, s23, 1
  s_add_u32 s44, s25, s24
  s_lshl_b32 s30, s21, 2
  s_add_u32 s30, s30, s44
  s_lshl_b32 s30, s30, 16
  s_lshl_b32 s25, s22, 7
  s_add_u32 s30, s30, s25
  s_lshl_b32 s45, s21, 4
  s_add_u32 s45, s45, s22
  s_lshl_b32 s45, s45, 7
  s_add_u32 s45, s45, 4096
  s_waitcnt vmcnt(12)
  s_barrier
  s_cmp_lg_u32 s20, 0
  s_cbranch_scc1 k2_s
  v_mov_b32 v14, s88
  v_lshlrev_b32 v15, 7, v2
  s_mov_b32 exec_lo, s86
  s_mov_b32 exec_hi, 0
  buffer_store_dword v14, v15, s[92:95], s87 offen sc1
  s_mov_b64 exec, -1
k2_s:
  v_lshlrev_b32 v15, 2, v2
  s_cmp_lg_u32 s20, 0
  s_cbranch_scc1 k2_p_ok
  s_mov_b64 exec, 268435455
k2_p:
  buffer_load_dword v14, v15, s[92:95], s45 offen sc1
  s_waitcnt vmcnt(0)
  v_cmp_ne_u32 vcc, s88, v14
  s_nop 4
  s_cbranch_vccnz k2_p
k2_p_ok:
  s_mov_b64 exec, -1
  s_barrier
  s_lshl_b32 s45, s21, 8
  s_add_u32 s45, s45, 36864
  buffer_load_dwordx4 v[64:67], v3, s[8:11], s26 offen offset:0 sc1
  buffer_load_dwordx4 v[68:71], v20, s[8:11], s26 offen offset:0 sc1
  buffer_load_dwordx4 v[72:75], v3, s[8:11], s26 offen offset:1024 sc1
  buffer_load_dwordx4 v[76:79], v20, s[8:11], s26 offen offset:1024 sc1
  buffer_load_dwordx4 v[80:83], v3, s[8:11], s26 offen offset:2048 sc1
  buffer_load_dwordx4 v[84:87], v20, s[8:11], s26 offen offset:2048 sc1
  buffer_load_dwordx4 v[88:91], v3, s[8:11], s26 offen offset:3072 sc1
  buffer_load_dwordx4 v[92:95], v20, s[8:11], s26 offen offset:3072 sc1
  s_add_u32 s26, s26, 4096
  buffer_load_dwordx4 v[96:99], v3, s[8:11], s26 offen offset:0 sc1
  buffer_load_dwordx4 v[100:103], v20, s[8:11], s26 offen offset:0 sc1
  buffer_load_dwordx4 v[104:107], v3, s[8:11], s26 offen offset:1024 sc1
  buffer_load_dwordx4 v[108:111], v20, s[8:11], s26 offen offset:1024 sc1
  buffer_load_dwordx4 v[112:115], v3, s[8:11], s26 offen offset:2048 sc1
  buffer_load_dwordx4 v[116:119], v20, s[8:11], s26 offen offset:2048 sc1
  buffer_load_dwordx4 v[120:123], v3, s[8:11], s26 offen offset:3072 sc1
  buffer_load_dwordx4 v[124:127], v20, s[8:11], s26 offen offset:3072 sc1
  s_add_u32 s26, s26, 4096
  buffer_load_dwordx4 v[128:131], v3, s[8:11], s26 offen offset:0 sc1
  buffer_load_dwordx4 v[132:135], v20, s[8:11], s26 offen offset:0 sc1
  buffer_load_dwordx4 v[136:139], v3, s[8:11], s26 offen offset:1024 sc1
  buffer_load_dwordx4 v[140:143], v20, s[8:11], s26 offen offset:1024 sc1
  buffer_load_dwordx4 v[144:147], v3, s[8:11], s26 offen offset:2048 sc1
  buffer_load_dwordx4 v[148:151], v20, s[8:11], s26 offen offset:2048 sc1
  buffer_load_dwordx4 v[152:155], v3, s[8:11], s26 offen offset:3072 sc1
  buffer_load_dwordx4 v[156:159], v20, s[8:11], s26 offen offset:3072 sc1
  s_add_u32 s26, s26, 4096
  s_waitcnt vmcnt(32)
  s_barrier
  ds_read_b64_tr_b16 v[32:33], v8 offset:0
  ds_read_b64_tr_b16 v[34:35], v8 offset:2048
  ds_read_b64_tr_b16 v[36:37], v9 offset:0
  ds_read_b64_tr_b16 v[38:39], v9 offset:2048
  ds_read_b64_tr_b16 v[40:41], v10 offset:0
  ds_read_b64_tr_b16 v[42:43], v10 offset:2048
  ds_read_b64_tr_b16 v[44:45], v11 offset:0
  ds_read_b64_tr_b16 v[46:47], v11 offset:2048
  s_waitcnt vmcnt(22) lgkmcnt(0)
  v_mfma_f32_16x16x32_bf16 v[224:227], v[32:35], v[64:67], v[224:227]
  ds_read_b64_tr_b16 v[48:49], v8 offset:4096
  ds_read_b64_tr_b16 v[50:51], v8 offset:6144
  s_add_u32 m0, s29, 49152
  v_mfma_f32_16x16x32_bf16 v[228:231], v[36:39], v[64:67], v[228:231]
  ds_read_b64_tr_b16 v[52:53], v9 offset:4096
  ds_read_b64_tr_b16 v[54:55], v9 offset:6144
  buffer_load_dwordx4 v4, s[12:15], s28 offen lds
  v_mfma_f32_16x16x32_bf16 v[232:235], v[40:43], v[64:67], v[232:235]
  ds_read_b64_tr_b16 v[56:57], v10 offset:4096
  ds_read_b64_tr_b16 v[58:59], v10 offset:6144
  s_add_u32 m0, s29, 50176
  v_mfma_f32_16x16x32_bf16 v[236:239], v[44:47], v[64:67], v[236:239]
  ds_read_b64_tr_b16 v[60:61], v11 offset:4096
  ds_read_b64_tr_b16 v[62:63], v11 offset:6144
  buffer_load_dwordx4 v5, s[12:15], s28 offen lds
  v_mfma_f32_16x16x32_bf16 v[252:255], v[44:47], v[68:71], v[252:255]
  v_mfma_f32_16x16x32_bf16 v[248:251], v[40:43], v[68:71], v[248:251]
  s_add_u32 m0, s29, 51200
  v_mfma_f32_16x16x32_bf16 v[244:247], v[36:39], v[68:71], v[244:247]
  buffer_load_dwordx4 v6, s[12:15], s28 offen lds
  v_mfma_f32_16x16x32_bf16 v[240:243], v[32:35], v[68:71], v[240:243]
  s_waitcnt vmcnt(23) lgkmcnt(0)
  v_mfma_f32_16x16x32_bf16 v[224:227], v[48:51], v[72:75], v[224:227]
  ds_read_b64_tr_b16 v[32:33], v8 offset:8192
  ds_read_b64_tr_b16 v[34:35], v8 offset:10240
  s_add_u32 m0, s29, 52224
  v_mfma_f32_16x16x32_bf16 v[228:231], v[52:55], v[72:75], v[228:231]
  ds_read_b64_tr_b16 v[36:37], v9 offset:8192
  ds_read_b64_tr_b16 v[38:39], v9 offset:10240
  buffer_load_dwordx4 v7, s[12:15], s28 offen lds
  s_add_u32 s28, s28, 262144
  v_mfma_f32_16x16x32_bf16 v[232:235], v[56:59], v[72:75], v[232:235]
  ds_read_b64_tr_b16 v[40:41], v10 offset:8192
  ds_read_b64_tr_b16 v[42:43], v10 offset:10240
  v_mfma_f32_16x16x32_bf16 v[236:239], v[60:63], v[72:75], v[236:239]
  ds_read_b64_tr_b16 v[44:45], v11 offset:8192
  ds_read_b64_tr_b16 v[46:47], v11 offset:10240
  buffer_load_dwordx4 v[160:163], v3, s[8:11], s26 offen offset:0 sc1
  v_mfma_f32_16x16x32_bf16 v[252:255], v[60:63], v[76:79], v[252:255]
  v_mfma_f32_16x16x32_bf16 v[248:251], v[56:59], v[76:79], v[248:251]
  v_mfma_f32_16x16x32_bf16 v[244:247], v[52:55], v[76:79], v[244:247]
  buffer_load_dwordx4 v[164:167], v20, s[8:11], s26 offen offset:0 sc1
  v_mfma_f32_16x16x32_bf16 v[240:243], v[48:51], v[76:79], v[240:243]
  s_waitcnt vmcnt(24) lgkmcnt(0)
  v_mfma_f32_16x16x32_bf16 v[224:227], v[32:35], v[80:83], v[224:227]
  ds_read_b64_tr_b16 v[48:49], v8 offset:12288
  ds_read_b64_tr_b16 v[50:51], v8 offset:14336
  v_mfma_f32_16x16x32_bf16 v[228:231], v[36:39], v[80:83], v[228:231]
  ds_read_b64_tr_b16 v[52:53], v9 offset:12288
  ds_read_b64_tr_b16 v[54:55], v9 offset:14336
  buffer_load_dwordx4 v[168:171], v3, s[8:11], s26 offen offset:1024 sc1
  v_mfma_f32_16x16x32_bf16 v[232:235], v[40:43], v[80:83], v[232:235]
  ds_read_b64_tr_b16 v[56:57], v10 offset:12288
  ds_read_b64_tr_b16 v[58:59], v10 offset:14336
  v_mfma_f32_16x16x32_bf16 v[236:239], v[44:47], v[80:83], v[236:239]
  ds_read_b64_tr_b16 v[60:61], v11 offset:12288
  ds_read_b64_tr_b16 v[62:63], v11 offset:14336
  buffer_load_dwordx4 v[172:175], v20, s[8:11], s26 offen offset:1024 sc1
  v_mfma_f32_16x16x32_bf16 v[252:255], v[44:47], v[84:87], v[252:255]
  v_mfma_f32_16x16x32_bf16 v[248:251], v[40:43], v[84:87], v[248:251]
  v_mfma_f32_16x16x32_bf16 v[244:247], v[36:39], v[84:87], v[244:247]
  buffer_load_dwordx4 v[176:179], v3, s[8:11], s26 offen offset:2048 sc1
  v_mfma_f32_16x16x32_bf16 v[240:243], v[32:35], v[84:87], v[240:243]
  s_waitcnt vmcnt(25) lgkmcnt(0)
  s_barrier
  v_mfma_f32_16x16x32_bf16 v[224:227], v[48:51], v[88:91], v[224:227]
  ds_read_b64_tr_b16 v[32:33], v8 offset:16384
  ds_read_b64_tr_b16 v[34:35], v8 offset:18432
  v_mfma_f32_16x16x32_bf16 v[228:231], v[52:55], v[88:91], v[228:231]
  ds_read_b64_tr_b16 v[36:37], v9 offset:16384
  ds_read_b64_tr_b16 v[38:39], v9 offset:18432
  buffer_load_dwordx4 v[180:183], v20, s[8:11], s26 offen offset:2048 sc1
  v_mfma_f32_16x16x32_bf16 v[232:235], v[56:59], v[88:91], v[232:235]
  ds_read_b64_tr_b16 v[40:41], v10 offset:16384
  ds_read_b64_tr_b16 v[42:43], v10 offset:18432
  v_mfma_f32_16x16x32_bf16 v[236:239], v[60:63], v[88:91], v[236:239]
  ds_read_b64_tr_b16 v[44:45], v11 offset:16384
  ds_read_b64_tr_b16 v[46:47], v11 offset:18432
  buffer_load_dwordx4 v[184:187], v3, s[8:11], s26 offen offset:3072 sc1
  v_mfma_f32_16x16x32_bf16 v[252:255], v[60:63], v[92:95], v[252:255]
  v_mfma_f32_16x16x32_bf16 v[248:251], v[56:59], v[92:95], v[248:251]
  v_mfma_f32_16x16x32_bf16 v[244:247], v[52:55], v[92:95], v[244:247]
  buffer_load_dwordx4 v[188:191], v20, s[8:11], s26 offen offset:3072 sc1
  s_add_u32 s26, s26, 4096
  v_mfma_f32_16x16x32_bf16 v[240:243], v[48:51], v[92:95], v[240:243]
  s_waitcnt vmcnt(26) lgkmcnt(0)
  v_mfma_f32_16x16x32_bf16 v[224:227], v[32:35], v[96:99], v[224:227]
  ds_read_b64_tr_b16 v[48:49], v8 offset:20480
  ds_read_b64_tr_b16 v[50:51], v8 offset:22528
  s_add_u32 m0, s29, 0
  v_mfma_f32_16x16x32_bf16 v[228:231], v[36:39], v[96:99], v[228:231]
  ds_read_b64_tr_b16 v[52:53], v9 offset:20480
  ds_read_b64_tr_b16 v[54:55], v9 offset:22528
  buffer_load_dwordx4 v4, s[12:15], s28 offen lds
  v_mfma_f32_16x16x32_bf16 v[232:235], v[40:43], v[96:99], v[232:235]
  ds_read_b64_tr_b16 v[56:57], v10 offset:20480
  ds_read_b64_tr_b16 v[58:59], v10 offset:22528
  s_add_u32 m0, s29, 1024
  v_mfma_f32_16x16x32_bf16 v[236:239], v[44:47], v[96:99], v[236:239]
  ds_read_b64_tr_b16 v[60:61], v11 offset:20480
  ds_read_b64_tr_b16 v[62:63], v11 offset:22528
  buffer_load_dwordx4 v5, s[12:15], s28 offen lds
  v_mfma_f32_16x16x32_bf16 v[252:255], v[44:47], v[100:103], v[252:255]
  v_mfma_f32_16x16x32_bf16 v[248:251], v[40:43], v[100:103], v[248:251]
  s_add_u32 m0, s29, 2048
  v_mfma_f32_16x16x32_bf16 v[244:247], v[36:39], v[100:103], v[244:247]
  buffer_load_dwordx4 v6, s[12:15], s28 offen lds
  v_mfma_f32_16x16x32_bf16 v[240:243], v[32:35], v[100:103], v[240:243]
  s_waitcnt vmcnt(27) lgkmcnt(0)
  v_mfma_f32_16x16x32_bf16 v[224:227], v[48:51], v[104:107], v[224:227]
  ds_read_b64_tr_b16 v[32:33], v8 offset:24576
  ds_read_b64_tr_b16 v[34:35], v8 offset:26624
  s_add_u32 m0, s29, 3072
  v_mfma_f32_16x16x32_bf16 v[228:231], v[52:55], v[104:107], v[228:231]
  ds_read_b64_tr_b16 v[36:37], v9 offset:24576
  ds_read_b64_tr_b16 v[38:39], v9 offset:26624
  buffer_load_dwordx4 v7, s[12:15], s28 offen lds
  s_add_u32 s28, s28, 262144
  v_mfma_f32_16x16x32_bf16 v[232:235], v[56:59], v[104:107], v[232:235]
  ds_read_b64_tr_b16 v[40:41], v10 offset:24576
  ds_read_b64_tr_b16 v[42:43], v10 offset:26624
  v_mfma_f32_16x16x32_bf16 v[236:239], v[60:63], v[104:107], v[236:239]
  ds_read_b64_tr_b16 v[44:45], v11 offset:24576
  ds_read_b64_tr_b16 v[46:47], v11 offset:26624
  buffer_load_dwordx4 v[64:67], v3, s[8:11], s26 offen offset:0 sc1
  v_mfma_f32_16x16x32_bf16 v[252:255], v[60:63], v[108:111], v[252:255]
  v_mfma_f32_16x16x32_bf16 v[248:251], v[56:59], v[108:111], v[248:251]
  v_mfma_f32_16x16x32_bf16 v[244:247], v[52:55], v[108:111], v[244:247]
  buffer_load_dwordx4 v[68:71], v20, s[8:11], s26 offen offset:0 sc1
  v_mfma_f32_16x16x32_bf16 v[240:243], v[48:51], v[108:111], v[240:243]
  s_waitcnt vmcnt(28) lgkmcnt(0)
  v_mfma_f32_16x16x32_bf16 v[224:227], v[32:35], v[112:115], v[224:227]
  ds_read_b64_tr_b16 v[48:49], v8 offset:28672
  ds_read_b64_tr_b16 v[50:51], v8 offset:30720
  v_mfma_f32_16x16x32_bf16 v[228:231], v[36:39], v[112:115], v[228:231]
  ds_read_b64_tr_b16 v[52:53], v9 offset:28672
  ds_read_b64_tr_b16 v[54:55], v9 offset:30720
  buffer_load_dwordx4 v[72:75], v3, s[8:11], s26 offen offset:1024 sc1
  v_mfma_f32_16x16x32_bf16 v[232:235], v[40:43], v[112:115], v[232:235]
  ds_read_b64_tr_b16 v[56:57], v10 offset:28672
  ds_read_b64_tr_b16 v[58:59], v10 offset:30720
  v_mfma_f32_16x16x32_bf16 v[236:239], v[44:47], v[112:115], v[236:239]
  ds_read_b64_tr_b16 v[60:61], v11 offset:28672
  ds_read_b64_tr_b16 v[62:63], v11 offset:30720
  buffer_load_dwordx4 v[76:79], v20, s[8:11], s26 offen offset:1024 sc1
  v_mfma_f32_16x16x32_bf16 v[252:255], v[44:47], v[116:119], v[252:255]
  v_mfma_f32_16x16x32_bf16 v[248:251], v[40:43], v[116:119], v[248:251]
  v_mfma_f32_16x16x32_bf16 v[244:247], v[36:39], v[116:119], v[244:247]
  buffer_load_dwordx4 v[80:83], v3, s[8:11], s26 offen offset:2048 sc1
  v_mfma_f32_16x16x32_bf16 v[240:243], v[32:35], v[116:119], v[240:243]
  s_waitcnt vmcnt(29) lgkmcnt(0)
  s_barrier
  v_mfma_f32_16x16x32_bf16 v[224:227], v[48:51], v[120:123], v[224:227]
  ds_read_b64_tr_b16 v[32:33], v8 offset:32768
  ds_read_b64_tr_b16 v[34:35], v8 offset:34816
  v_mfma_f32_16x16x32_bf16 v[228:231], v[52:55], v[120:123], v[228:231]
  ds_read_b64_tr_b16 v[36:37], v9 offset:32768
  ds_read_b64_tr_b16 v[38:39], v9 offset:34816
  buffer_load_dwordx4 v[84:87], v20, s[8:11], s26 offen offset:2048 sc1
  v_mfma_f32_16x16x32_bf16 v[232:235], v[56:59], v[120:123], v[232:235]
  ds_read_b64_tr_b16 v[40:41], v10 offset:32768
  ds_read_b64_tr_b16 v[42:43], v10 offset:34816
  v_mfma_f32_16x16x32_bf16 v[236:239], v[60:63], v[120:123], v[236:239]
  ds_read_b64_tr_b16 v[44:45], v11 offset:32768
  ds_read_b64_tr_b16 v[46:47], v11 offset:34816
  buffer_load_dwordx4 v[88:91], v3, s[8:11], s26 offen offset:3072 sc1
  v_mfma_f32_16x16x32_bf16 v[252:255], v[60:63], v[124:127], v[252:255]
  v_mfma_f32_16x16x32_bf16 v[248:251], v[56:59], v[124:127], v[248:251]
  v_mfma_f32_16x16x32_bf16 v[244:247], v[52:55], v[124:127], v[244:247]
  buffer_load_dwordx4 v[92:95], v20, s[8:11], s26 offen offset:3072 sc1
  s_add_u32 s26, s26, 4096
  v_mfma_f32_16x16x32_bf16 v[240:243], v[48:51], v[124:127], v[240:243]
  s_waitcnt vmcnt(30) lgkmcnt(0)
  v_mfma_f32_16x16x32_bf16 v[224:227], v[32:35], v[128:131], v[224:227]
  ds_read_b64_tr_b16 v[48:49], v8 offset:36864
  ds_read_b64_tr_b16 v[50:51], v8 offset:38912
  s_add_u32 m0, s29, 16384
  v_mfma_f32_16x16x32_bf16 v[228:231], v[36:39], v[128:131], v[228:231]
  ds_read_b64_tr_b16 v[52:53], v9 offset:36864
  ds_read_b64_tr_b16 v[54:55], v9 offset:38912
  buffer_load_dwordx4 v4, s[12:15], s28 offen lds
  v_mfma_f32_16x16x32_bf16 v[232:235], v[40:43], v[128:131], v[232:235]
  ds_read_b64_tr_b16 v[56:57], v10 offset:36864
  ds_read_b64_tr_b16 v[58:59], v10 offset:38912
  s_add_u32 m0, s29, 17408
  v_mfma_f32_16x16x32_bf16 v[236:239], v[44:47], v[128:131], v[236:239]
  ds_read_b64_tr_b16 v[60:61], v11 offset:36864
  ds_read_b64_tr_b16 v[62:63], v11 offset:38912
  buffer_load_dwordx4 v5, s[12:15], s28 offen lds
  v_mfma_f32_16x16x32_bf16 v[252:255], v[44:47], v[132:135], v[252:255]
  v_mfma_f32_16x16x32_bf16 v[248:251], v[40:43], v[132:135], v[248:251]
  s_add_u32 m0, s29, 18432
  v_mfma_f32_16x16x32_bf16 v[244:247], v[36:39], v[132:135], v[244:247]
  buffer_load_dwordx4 v6, s[12:15], s28 offen lds
  v_mfma_f32_16x16x32_bf16 v[240:243], v[32:35], v[132:135], v[240:243]
  s_waitcnt vmcnt(31) lgkmcnt(0)
  v_mfma_f32_16x16x32_bf16 v[224:227], v[48:51], v[136:139], v[224:227]
  ds_read_b64_tr_b16 v[32:33], v8 offset:40960
  ds_read_b64_tr_b16 v[34:35], v8 offset:43008
  s_add_u32 m0, s29, 19456
  v_mfma_f32_16x16x32_bf16 v[228:231], v[52:55], v[136:139], v[228:231]
  ds_read_b64_tr_b16 v[36:37], v9 offset:40960
  ds_read_b64_tr_b16 v[38:39], v9 offset:43008
  buffer_load_dwordx4 v7, s[12:15], s28 offen lds
  s_add_u32 s28, s28, 262144
  v_mfma_f32_16x16x32_bf16 v[232:235], v[56:59], v[136:139], v[232:235]
  ds_read_b64_tr_b16 v[40:41], v10 offset:40960
  ds_read_b64_tr_b16 v[42:43], v10 offset:43008
  v_mfma_f32_16x16x32_bf16 v[236:239], v[60:63], v[136:139], v[236:239]
  ds_read_b64_tr_b16 v[44:45], v11 offset:40960
  ds_read_b64_tr_b16 v[46:47], v11 offset:43008
  buffer_load_dwordx4 v[96:99], v3, s[8:11], s26 offen offset:0 sc1
  v_mfma_f32_16x16x32_bf16 v[252:255], v[60:63], v[140:143], v[252:255]
  v_mfma_f32_16x16x32_bf16 v[248:251], v[56:59], v[140:143], v[248:251]
  v_mfma_f32_16x16x32_bf16 v[244:247], v[52:55], v[140:143], v[244:247]
  buffer_load_dwordx4 v[100:103], v20, s[8:11], s26 offen offset:0 sc1
  v_mfma_f32_16x16x32_bf16 v[240:243], v[48:51], v[140:143], v[240:243]
  s_waitcnt vmcnt(32) lgkmcnt(0)
  v_mfma_f32_16x16x32_bf16 v[224:227], v[32:35], v[144:147], v[224:227]
  ds_read_b64_tr_b16 v[48:49], v8 offset:45056
  ds_read_b64_tr_b16 v[50:51], v8 offset:47104
  v_mfma_f32_16x16x32_bf16 v[228:231], v[36:39], v[144:147], v[228:231]
  ds_read_b64_tr_b16 v[52:53], v9 offset:45056
  ds_read_b64_tr_b16 v[54:55], v9 offset:47104
  buffer_load_dwordx4 v[104:107], v3, s[8:11], s26 offen offset:1024 sc1
  v_mfma_f32_16x16x32_bf16 v[232:235], v[40:43], v[144:147], v[232:235]
  ds_read_b64_tr_b16 v[56:57], v10 offset:45056
  ds_read_b64_tr_b16 v[58:59], v10 offset:47104
  v_mfma_f32_16x16x32_bf16 v[236:239], v[44:47], v[144:147], v[236:239]
  ds_read_b64_tr_b16 v[60:61], v11 offset:45056
  ds_read_b64_tr_b16 v[62:63], v11 offset:47104
  buffer_load_dwordx4 v[108:111], v20, s[8:11], s26 offen offset:1024 sc1
  v_mfma_f32_16x16x32_bf16 v[252:255], v[44:47], v[148:151], v[252:255]
  v_mfma_f32_16x16x32_bf16 v[248:251], v[40:43], v[148:151], v[248:251]
  v_mfma_f32_16x16x32_bf16 v[244:247], v[36:39], v[148:151], v[244:247]
  buffer_load_dwordx4 v[112:115], v3, s[8:11], s26 offen offset:2048 sc1
  v_mfma_f32_16x16x32_bf16 v[240:243], v[32:35], v[148:151], v[240:243]
  s_waitcnt vmcnt(29) lgkmcnt(0)
  s_barrier
  v_mfma_f32_16x16x32_bf16 v[224:227], v[48:51], v[152:155], v[224:227]
  ds_read_b64_tr_b16 v[32:33], v8 offset:49152
  ds_read_b64_tr_b16 v[34:35], v8 offset:51200
  v_mfma_f32_16x16x32_bf16 v[228:231], v[52:55], v[152:155], v[228:231]
  ds_read_b64_tr_b16 v[36:37], v9 offset:49152
  ds_read_b64_tr_b16 v[38:39], v9 offset:51200
  buffer_load_dwordx4 v[116:119], v20, s[8:11], s26 offen offset:2048 sc1
  v_mfma_f32_16x16x32_bf16 v[232:235], v[56:59], v[152:155], v[232:235]
  ds_read_b64_tr_b16 v[40:41], v10 offset:49152
  ds_read_b64_tr_b16 v[42:43], v10 offset:51200
  v_mfma_f32_16x16x32_bf16 v[236:239], v[60:63], v[152:155], v[236:239]
  ds_read_b64_tr_b16 v[44:45], v11 offset:49152
  ds_read_b64_tr_b16 v[46:47], v11 offset:51200
  buffer_load_dwordx4 v[120:123], v3, s[8:11], s26 offen offset:3072 sc1
  v_mfma_f32_16x16x32_bf16 v[252:255], v[60:63], v[156:159], v[252:255]
  v_mfma_f32_16x16x32_bf16 v[248:251], v[56:59], v[156:159], v[248:251]
  v_mfma_f32_16x16x32_bf16 v[244:247], v[52:55], v[156:159], v[244:247]
  buffer_load_dwordx4 v[124:127], v20, s[8:11], s26 offen offset:3072 sc1
  s_add_u32 s26, s26, 4096
  v_mfma_f32_16x16x32_bf16 v[240:243], v[48:51], v[156:159], v[240:243]
  s_waitcnt vmcnt(30) lgkmcnt(0)
  v_mfma_f32_16x16x32_bf16 v[224:227], v[32:35], v[160:163], v[224:227]
  ds_read_b64_tr_b16 v[48:49], v8 offset:53248
  ds_read_b64_tr_b16 v[50:51], v8 offset:55296
  s_add_u32 m0, s29, 32768
  v_mfma_f32_16x16x32_bf16 v[228:231], v[36:39], v[160:163], v[228:231]
  ds_read_b64_tr_b16 v[52:53], v9 offset:53248
  ds_read_b64_tr_b16 v[54:55], v9 offset:55296
  buffer_load_dwordx4 v4, s[12:15], s28 offen lds
  v_mfma_f32_16x16x32_bf16 v[232:235], v[40:43], v[160:163], v[232:235]
  ds_read_b64_tr_b16 v[56:57], v10 offset:53248
  ds_read_b64_tr_b16 v[58:59], v10 offset:55296
  s_add_u32 m0, s29, 33792
  v_mfma_f32_16x16x32_bf16 v[236:239], v[44:47], v[160:163], v[236:239]
  ds_read_b64_tr_b16 v[60:61], v11 offset:53248
  ds_read_b64_tr_b16 v[62:63], v11 offset:55296
  buffer_load_dwordx4 v5, s[12:15], s28 offen lds
  v_mfma_f32_16x16x32_bf16 v[252:255], v[44:47], v[164:167], v[252:255]
  v_mfma_f32_16x16x32_bf16 v[248:251], v[40:43], v[164:167], v[248:251]
  s_add_u32 m0, s29, 34816
  v_mfma_f32_16x16x32_bf16 v[244:247], v[36:39], v[164:167], v[244:247]
  buffer_load_dwordx4 v6, s[12:15], s28 offen lds
  v_mfma_f32_16x16x32_bf16 v[240:243], v[32:35], v[164:167], v[240:243]
  s_waitcnt vmcnt(31) lgkmcnt(0)
  v_mfma_f32_16x16x32_bf16 v[224:227], v[48:51], v[168:171], v[224:227]
  ds_read_b64_tr_b16 v[32:33], v8 offset:57344
  ds_read_b64_tr_b16 v[34:35], v8 offset:59392
  s_add_u32 m0, s29, 35840
  v_mfma_f32_16x16x32_bf16 v[228:231], v[52:55], v[168:171], v[228:231]
  ds_read_b64_tr_b16 v[36:37], v9 offset:57344
  ds_read_b64_tr_b16 v[38:39], v9 offset:59392
  buffer_load_dwordx4 v7, s[12:15], s28 offen lds
  s_add_u32 s28, s28, 262144
  v_mfma_f32_16x16x32_bf16 v[232:235], v[56:59], v[168:171], v[232:235]
  ds_read_b64_tr_b16 v[40:41], v10 offset:57344
  ds_read_b64_tr_b16 v[42:43], v10 offset:59392
  v_mfma_f32_16x16x32_bf16 v[236:239], v[60:63], v[168:171], v[236:239]
  ds_read_b64_tr_b16 v[44:45], v11 offset:57344
  ds_read_b64_tr_b16 v[46:47], v11 offset:59392
  buffer_load_dwordx4 v[128:131], v3, s[8:11], s26 offen offset:0 sc1
  v_mfma_f32_16x16x32_bf16 v[252:255], v[60:63], v[172:175], v[252:255]
  v_mfma_f32_16x16x32_bf16 v[248:251], v[56:59], v[172:175], v[248:251]
  v_mfma_f32_16x16x32_bf16 v[244:247], v[52:55], v[172:175], v[244:247]
  buffer_load_dwordx4 v[132:135], v20, s[8:11], s26 offen offset:0 sc1
  v_mfma_f32_16x16x32_bf16 v[240:243], v[48:51], v[172:175], v[240:243]
  s_waitcnt vmcnt(32) lgkmcnt(0)
  v_mfma_f32_16x16x32_bf16 v[224:227], v[32:35], v[176:179], v[224:227]
  ds_read_b64_tr_b16 v[48:49], v8 offset:61440
  ds_read_b64_tr_b16 v[50:51], v8 offset:63488
  v_mfma_f32_16x16x32_bf16 v[228:231], v[36:39], v[176:179], v[228:231]
  ds_read_b64_tr_b16 v[52:53], v9 offset:61440
  ds_read_b64_tr_b16 v[54:55], v9 offset:63488
  buffer_load_dwordx4 v[136:139], v3, s[8:11], s26 offen offset:1024 sc1
  v_mfma_f32_16x16x32_bf16 v[232:235], v[40:43], v[176:179], v[232:235]
  ds_read_b64_tr_b16 v[56:57], v10 offset:61440
  ds_read_b64_tr_b16 v[58:59], v10 offset:63488
  v_mfma_f32_16x16x32_bf16 v[236:239], v[44:47], v[176:179], v[236:239]
  ds_read_b64_tr_b16 v[60:61], v11 offset:61440
  ds_read_b64_tr_b16 v[62:63], v11 offset:63488
  buffer_load_dwordx4 v[140:143], v20, s[8:11], s26 offen offset:1024 sc1
  v_mfma_f32_16x16x32_bf16 v[252:255], v[44:47], v[180:183], v[252:255]
  v_mfma_f32_16x16x32_bf16 v[248:251], v[40:43], v[180:183], v[248:251]
  v_mfma_f32_16x16x32_bf16 v[244:247], v[36:39], v[180:183], v[244:247]
  buffer_load_dwordx4 v[144:147], v3, s[8:11], s26 offen offset:2048 sc1
  v_mfma_f32_16x16x32_bf16 v[240:243], v[32:35], v[180:183], v[240:243]
  s_waitcnt vmcnt(29) lgkmcnt(0)
  s_barrier
  v_mfma_f32_16x16x32_bf16 v[224:227], v[48:51], v[184:187], v[224:227]
  ds_read_b64_tr_b16 v[32:33], v8 offset:0
  ds_read_b64_tr_b16 v[34:35], v8 offset:2048
  v_mfma_f32_16x16x32_bf16 v[228:231], v[52:55], v[184:187], v[228:231]
  ds_read_b64_tr_b16 v[36:37], v9 offset:0
  ds_read_b64_tr_b16 v[38:39], v9 offset:2048
  buffer_load_dwordx4 v[148:151], v20, s[8:11], s26 offen offset:2048 sc1
  v_mfma_f32_16x16x32_bf16 v[232:235], v[56:59], v[184:187], v[232:235]
  ds_read_b64_tr_b16 v[40:41], v10 offset:0
  ds_read_b64_tr_b16 v[42:43], v10 offset:2048
  v_mfma_f32_16x16x32_bf16 v[236:239], v[60:63], v[184:187], v[236:239]
  ds_read_b64_tr_b16 v[44:45], v11 offset:0
  ds_read_b64_tr_b16 v[46:47], v11 offset:2048
  buffer_load_dwordx4 v[152:155], v3, s[8:11], s26 offen offset:3072 sc1
  v_mfma_f32_16x16x32_bf16 v[252:255], v[60:63], v[188:191], v[252:255]
  v_mfma_f32_16x16x32_bf16 v[248:251], v[56:59], v[188:191], v[248:251]
  v_mfma_f32_16x16x32_bf16 v[244:247], v[52:55], v[188:191], v[244:247]
  buffer_load_dwordx4 v[156:159], v20, s[8:11], s26 offen offset:3072 sc1
  s_add_u32 s26, s26, 4096
  v_mfma_f32_16x16x32_bf16 v[240:243], v[48:51], v[188:191], v[240:243]
  s_mov_b32 s47, 5
.p2align 3
k2_loop:
  s_waitcnt vmcnt(30) lgkmcnt(0)
  v_mfma_f32_16x16x32_bf16 v[224:227], v[32:35], v[64:67], v[224:227]
  ds_read_b64_tr_b16 v[48:49], v8 offset:4096
  ds_read_b64_tr_b16 v[50:51], v8 offset:6144
  s_add_u32 m0, s29, 49152
  v_mfma_f32_16x16x32_bf16 v[228:231], v[36:39], v[64:67], v[228:231]
  ds_read_b64_tr_b16 v[52:53], v9 offset:4096
  ds_read_b64_tr_b16 v[54:55], v9 offset:6144
  buffer_load_dwordx4 v4, s[12:15], s28 offen lds
  v_mfma_f32_16x16x32_bf16 v[232:235], v[40:43], v[64:67], v[232:235]
  ds_read_b64_tr_b16 v[56:57], v10 offset:4096
  ds_read_b64_tr_b16 v[58:59], v10 offset:6144
  s_add_u32 m0, s29, 50176
  v_mfma_f32_16x16x32_bf16 v[236:239], v[44:47], v[64:67], v[236:239]
  ds_read_b64_tr_b16 v[60:61], v11 offset:4096
  ds_read_b64_tr_b16 v[62:63], v11 offset:6144
  buffer_load_dwordx4 v5, s[12:15], s28 offen lds
  v_mfma_f32_16x16x32_bf16 v[252:255], v[44:47], v[68:71], v[252:255]
  v_mfma_f32_16x16x32_bf16 v[248:251], v[40:43], v[68:71], v[248:251]
  s_add_u32 m0, s29, 51200
  v_mfma_f32_16x16x32_bf16 v[244:247], v[36:39], v[68:71], v[244:247]
  buffer_load_dwordx4 v6, s[12:15], s28 offen lds
  v_mfma_f32_16x16x32_bf16 v[240:243], v[32:35], v[68:71], v[240:243]
  s_waitcnt vmcnt(31) lgkmcnt(0)
  v_mfma_f32_16x16x32_bf16 v[224:227], v[48:51], v[72:75], v[224:227]
  ds_read_b64_tr_b16 v[32:33], v8 offset:8192
  ds_read_b64_tr_b16 v[34:35], v8 offset:10240
  s_add_u32 m0, s29, 52224
  v_mfma_f32_16x16x32_bf16 v[228:231], v[52:55], v[72:75], v[228:231]
  ds_read_b64_tr_b16 v[36:37], v9 offset:8192
  ds_read_b64_tr_b16 v[38:39], v9 offset:10240
  buffer_load_dwordx4 v7, s[12:15], s28 offen lds
  s_add_u32 s28, s28, 262144
  v_mfma_f32_16x16x32_bf16 v[232:235], v[56:59], v[72:75], v[232:235]
  ds_read_b64_tr_b16 v[40:41], v10 offset:8192
  ds_read_b64_tr_b16 v[42:43], v10 offset:10240
  v_mfma_f32_16x16x32_bf16 v[236:239], v[60:63], v[72:75], v[236:239]
  ds_read_b64_tr_b16 v[44:45], v11 offset:8192
  ds_read_b64_tr_b16 v[46:47], v11 offset:10240
  buffer_load_dwordx4 v[160:163], v3, s[8:11], s26 offen offset:0 sc1
  v_mfma_f32_16x16x32_bf16 v[252:255], v[60:63], v[76:79], v[252:255]
  v_mfma_f32_16x16x32_bf16 v[248:251], v[56:59], v[76:79], v[248:251]
  v_mfma_f32_16x16x32_bf16 v[244:247], v[52:55], v[76:79], v[244:247]
  buffer_load_dwordx4 v[164:167], v20, s[8:11], s26 offen offset:0 sc1
  v_mfma_f32_16x16x32_bf16 v[240:243], v[48:51], v[76:79], v[240:243]
  s_waitcnt vmcnt(32) lgkmcnt(0)
  v_mfma_f32_16x16x32_bf16 v[224:227], v[32:35], v[80:83], v[224:227]
  ds_read_b64_tr_b16 v[48:49], v8 offset:12288
  ds_read_b64_tr_b16 v[50:51], v8 offset:14336
  v_mfma_f32_16x16x32_bf16 v[228:231], v[36:39], v[80:83], v[228:231]
  ds_read_b64_tr_b16 v[52:53], v9 offset:12288
  ds_read_b64_tr_b16 v[54:55], v9 offset:14336
  buffer_load_dwordx4 v[168:171], v3, s[8:11], s26 offen offset:1024 sc1
  v_mfma_f32_16x16x32_bf16 v[232:235], v[40:43], v[80:83], v[232:235]
  ds_read_b64_tr_b16 v[56:57], v10 offset:12288
  ds_read_b64_tr_b16 v[58:59], v10 offset:14336
  v_mfma_f32_16x16x32_bf16 v[236:239], v[44:47], v[80:83], v[236:239]
  ds_read_b64_tr_b16 v[60:61], v11 offset:12288
  ds_read_b64_tr_b16 v[62:63], v11 offset:14336
  buffer_load_dwordx4 v[172:175], v20, s[8:11], s26 offen offset:1024 sc1
  v_mfma_f32_16x16x32_bf16 v[252:255], v[44:47], v[84:87], v[252:255]
  v_mfma_f32_16x16x32_bf16 v[248:251], v[40:43], v[84:87], v[248:251]
  v_mfma_f32_16x16x32_bf16 v[244:247], v[36:39], v[84:87], v[244:247]
  buffer_load_dwordx4 v[176:179], v3, s[8:11], s26 offen offset:2048 sc1
  v_mfma_f32_16x16x32_bf16 v[240:243], v[32:35], v[84:87], v[240:243]
  s_waitcnt vmcnt(29) lgkmcnt(0)
  s_barrier
  v_mfma_f32_16x16x32_bf16 v[224:227], v[48:51], v[88:91], v[224:227]
  ds_read_b64_tr_b16 v[32:33], v8 offset:16384
  ds_read_b64_tr_b16 v[34:35], v8 offset:18432
  v_mfma_f32_16x16x32_bf16 v[228:231], v[52:55], v[88:91], v[228:231]
  ds_read_b64_tr_b16 v[36:37], v9 offset:16384
  ds_read_b64_tr_b16 v[38:39], v9 offset:18432
  buffer_load_dwordx4 v[180:183], v20, s[8:11], s26 offen offset:2048 sc1
  v_mfma_f32_16x16x32_bf16 v[232:235], v[56:59], v[88:91], v[232:235]
  ds_read_b64_tr_b16 v[40:41], v10 offset:16384
  ds_read_b64_tr_b16 v[42:43], v10 offset:18432
  v_mfma_f32_16x16x32_bf16 v[236:239], v[60:63], v[88:91], v[236:239]
  ds_read_b64_tr_b16 v[44:45], v11 offset:16384
  ds_read_b64_tr_b16 v[46:47], v11 offset:18432
  buffer_load_dwordx4 v[184:187], v3, s[8:11], s26 offen offset:3072 sc1
  v_mfma_f32_16x16x32_bf16 v[252:255], v[60:63], v[92:95], v[252:255]
  v_mfma_f32_16x16x32_bf16 v[248:251], v[56:59], v[92:95], v[248:251]
  v_mfma_f32_16x16x32_bf16 v[244:247], v[52:55], v[92:95], v[244:247]
  buffer_load_dwordx4 v[188:191], v20, s[8:11], s26 offen offset:3072 sc1
  s_add_u32 s26, s26, 4096
  v_mfma_f32_16x16x32_bf16 v[240:243], v[48:51], v[92:95], v[240:243]
  s_waitcnt vmcnt(30) lgkmcnt(0)
  v_mfma_f32_16x16x32_bf16 v[224:227], v[32:35], v[96:99], v[224:227]
  ds_read_b64_tr_b16 v[48:49], v8 offset:20480
  ds_read_b64_tr_b16 v[50:51], v8 offset:22528
  s_add_u32 m0, s29, 0
  v_mfma_f32_16x16x32_bf16 v[228:231], v[36:39], v[96:99], v[228:231]
  ds_read_b64_tr_b16 v[52:53], v9 offset:20480
  ds_read_b64_tr_b16 v[54:55], v9 offset:22528
  buffer_load_dwordx4 v4, s[12:15], s28 offen lds
  v_mfma_f32_16x16x32_bf16 v[232:235], v[40:43], v[96:99], v[232:235]
  ds_read_b64_tr_b16 v[56:57], v10 offset:20480
  ds_read_b64_tr_b16 v[58:59], v10 offset:22528
  s_add_u32 m0, s29, 1024
  v_mfma_f32_16x16x32_bf16 v[236:239], v[44:47], v[96:99], v[236:239]
  ds_read_b64_tr_b16 v[60:61], v11 offset:20480
  ds_read_b64_tr_b16 v[62:63], v11 offset:22528
  buffer_load_dwordx4 v5, s[12:15], s28 offen lds
  v_mfma_f32_16x16x32_bf16 v[252:255], v[44:47], v[100:103], v[252:255]
  v_mfma_f32_16x16x32_bf16 v[248:251], v[40:43], v[100:103], v[248:251]
  s_add_u32 m0, s29, 2048
  v_mfma_f32_16x16x32_bf16 v[244:247], v[36:39], v[100:103], v[244:247]
  buffer_load_dwordx4 v6, s[12:15], s28 offen lds
  v_mfma_f32_16x16x32_bf16 v[240:243], v[32:35], v[100:103], v[240:243]
  s_waitcnt vmcnt(31) lgkmcnt(0)
  v_mfma_f32_16x16x32_bf16 v[224:227], v[48:51], v[104:107], v[224:227]
  ds_read_b64_tr_b16 v[32:33], v8 offset:24576
  ds_read_b64_tr_b16 v[34:35], v8 offset:26624
  s_add_u32 m0, s29, 3072
  v_mfma_f32_16x16x32_bf16 v[228:231], v[52:55], v[104:107], v[228:231]
  ds_read_b64_tr_b16 v[36:37], v9 offset:24576
  ds_read_b64_tr_b16 v[38:39], v9 offset:26624
  buffer_load_dwordx4 v7, s[12:15], s28 offen lds
  s_add_u32 s28, s28, 262144
  v_mfma_f32_16x16x32_bf16 v[232:235], v[56:59], v[104:107], v[232:235]
  ds_read_b64_tr_b16 v[40:41], v10 offset:24576
  ds_read_b64_tr_b16 v[42:43], v10 offset:26624
  v_mfma_f32_16x16x32_bf16 v[236:239], v[60:63], v[104:107], v[236:239]
  ds_read_b64_tr_b16 v[44:45], v11 offset:24576
  ds_read_b64_tr_b16 v[46:47], v11 offset:26624
  buffer_load_dwordx4 v[64:67], v3, s[8:11], s26 offen offset:0 sc1
  v_mfma_f32_16x16x32_bf16 v[252:255], v[60:63], v[108:111], v[252:255]
  v_mfma_f32_16x16x32_bf16 v[248:251], v[56:59], v[108:111], v[248:251]
  v_mfma_f32_16x16x32_bf16 v[244:247], v[52:55], v[108:111], v[244:247]
  buffer_load_dwordx4 v[68:71], v20, s[8:11], s26 offen offset:0 sc1
  v_mfma_f32_16x16x32_bf16 v[240:243], v[48:51], v[108:111], v[240:243]
  s_waitcnt vmcnt(32) lgkmcnt(0)
  v_mfma_f32_16x16x32_bf16 v[224:227], v[32:35], v[112:115], v[224:227]
  ds_read_b64_tr_b16 v[48:49], v8 offset:28672
  ds_read_b64_tr_b16 v[50:51], v8 offset:30720
  v_mfma_f32_16x16x32_bf16 v[228:231], v[36:39], v[112:115], v[228:231]
  ds_read_b64_tr_b16 v[52:53], v9 offset:28672
  ds_read_b64_tr_b16 v[54:55], v9 offset:30720
  buffer_load_dwordx4 v[72:75], v3, s[8:11], s26 offen offset:1024 sc1
  v_mfma_f32_16x16x32_bf16 v[232:235], v[40:43], v[112:115], v[232:235]
  ds_read_b64_tr_b16 v[56:57], v10 offset:28672
  ds_read_b64_tr_b16 v[58:59], v10 offset:30720
  v_mfma_f32_16x16x32_bf16 v[236:239], v[44:47], v[112:115], v[236:239]
  ds_read_b64_tr_b16 v[60:61], v11 offset:28672
  ds_read_b64_tr_b16 v[62:63], v11 offset:30720
  buffer_load_dwordx4 v[76:79], v20, s[8:11], s26 offen offset:1024 sc1
  v_mfma_f32_16x16x32_bf16 v[252:255], v[44:47], v[116:119], v[252:255]
  v_mfma_f32_16x16x32_bf16 v[248:251], v[40:43], v[116:119], v[248:251]
  v_mfma_f32_16x16x32_bf16 v[244:247], v[36:39], v[116:119], v[244:247]
  buffer_load_dwordx4 v[80:83], v3, s[8:11], s26 offen offset:2048 sc1
  v_mfma_f32_16x16x32_bf16 v[240:243], v[32:35], v[116:119], v[240:243]
  s_waitcnt vmcnt(29) lgkmcnt(0)
  s_barrier
  v_mfma_f32_16x16x32_bf16 v[224:227], v[48:51], v[120:123], v[224:227]
  ds_read_b64_tr_b16 v[32:33], v8 offset:32768
  ds_read_b64_tr_b16 v[34:35], v8 offset:34816
  v_mfma_f32_16x16x32_bf16 v[228:231], v[52:55], v[120:123], v[228:231]
  ds_read_b64_tr_b16 v[36:37], v9 offset:32768
  ds_read_b64_tr_b16 v[38:39], v9 offset:34816
  buffer_load_dwordx4 v[84:87], v20, s[8:11], s26 offen offset:2048 sc1
  v_mfma_f32_16x16x32_bf16 v[232:235], v[56:59], v[120:123], v[232:235]
  ds_read_b64_tr_b16 v[40:41], v10 offset:32768
  ds_read_b64_tr_b16 v[42:43], v10 offset:34816
  v_mfma_f32_16x16x32_bf16 v[236:239], v[60:63], v[120:123], v[236:239]
  ds_read_b64_tr_b16 v[44:45], v11 offset:32768
  ds_read_b64_tr_b16 v[46:47], v11 offset:34816
  buffer_load_dwordx4 v[88:91], v3, s[8:11], s26 offen offset:3072 sc1
  v_mfma_f32_16x16x32_bf16 v[252:255], v[60:63], v[124:127], v[252:255]
  v_mfma_f32_16x16x32_bf16 v[248:251], v[56:59], v[124:127], v[248:251]
  v_mfma_f32_16x16x32_bf16 v[244:247], v[52:55], v[124:127], v[244:247]
  buffer_load_dwordx4 v[92:95], v20, s[8:11], s26 offen offset:3072 sc1
  s_add_u32 s26, s26, 4096
  v_mfma_f32_16x16x32_bf16 v[240:243], v[48:51], v[124:127], v[240:243]
  s_waitcnt vmcnt(30) lgkmcnt(0)
  v_mfma_f32_16x16x32_bf16 v[224:227], v[32:35], v[128:131], v[224:227]
  ds_read_b64_tr_b16 v[48:49], v8 offset:36864
  ds_read_b64_tr_b16 v[50:51], v8 offset:38912
  s_add_u32 m0, s29, 16384
  v_mfma_f32_16x16x32_bf16 v[228:231], v[36:39], v[128:131], v[228:231]
  ds_read_b64_tr_b16 v[52:53], v9 offset:36864
  ds_read_b64_tr_b16 v[54:55], v9 offset:38912
  buffer_load_dwordx4 v4, s[12:15], s28 offen lds
  v_mfma_f32_16x16x32_bf16 v[232:235], v[40:43], v[128:131], v[232:235]
  ds_read_b64_tr_b16 v[56:57], v10 offset:36864
  ds_read_b64_tr_b16 v[58:59], v10 offset:38912
  s_add_u32 m0, s29, 17408
  v_mfma_f32_16x16x32_bf16 v[236:239], v[44:47], v[128:131], v[236:239]
  ds_read_b64_tr_b16 v[60:61], v11 offset:36864
  ds_read_b64_tr_b16 v[62:63], v11 offset:38912
  buffer_load_dwordx4 v5, s[12:15], s28 offen lds
  v_mfma_f32_16x16x32_bf16 v[252:255], v[44:47], v[132:135], v[252:255]
  v_mfma_f32_16x16x32_bf16 v[248:251], v[40:43], v[132:135], v[248:251]
  s_add_u32 m0, s29, 18432
  v_mfma_f32_16x16x32_bf16 v[244:247], v[36:39], v[132:135], v[244:247]
  buffer_load_dwordx4 v6, s[12:15], s28 offen lds
  v_mfma_f32_16x16x32_bf16 v[240:243], v[32:35], v[132:135], v[240:243]
  s_waitcnt vmcnt(31) lgkmcnt(0)
  v_mfma_f32_16x16x32_bf16 v[224:227], v[48:51], v[136:139], v[224:227]
  ds_read_b64_tr_b16 v[32:33], v8 offset:40960
  ds_read_b64_tr_b16 v[34:35], v8 offset:43008
  s_add_u32 m0, s29, 19456
  v_mfma_f32_16x16x32_bf16 v[228:231], v[52:55], v[136:139], v[228:231]
  ds_read_b64_tr_b16 v[36:37], v9 offset:40960
  ds_read_b64_tr_b16 v[38:39], v9 offset:43008
  buffer_load_dwordx4 v7, s[12:15], s28 offen lds
  s_add_u32 s28, s28, 262144
  v_mfma_f32_16x16x32_bf16 v[232:235], v[56:59], v[136:139], v[232:235]
  ds_read_b64_tr_b16 v[40:41], v10 offset:40960
  ds_read_b64_tr_b16 v[42:43], v10 offset:43008
  v_mfma_f32_16x16x32_bf16 v[236:239], v[60:63], v[136:139], v[236:239]
  ds_read_b64_tr_b16 v[44:45], v11 offset:40960
  ds_read_b64_tr_b16 v[46:47], v11 offset:43008
  buffer_load_dwordx4 v[96:99], v3, s[8:11], s26 offen offset:0 sc1
  v_mfma_f32_16x16x32_bf16 v[252:255], v[60:63], v[140:143], v[252:255]
  v_mfma_f32_16x16x32_bf16 v[248:251], v[56:59], v[140:143], v[248:251]
  v_mfma_f32_16x16x32_bf16 v[244:247], v[52:55], v[140:143], v[244:247]
  buffer_load_dwordx4 v[100:103], v20, s[8:11], s26 offen offset:0 sc1
  v_mfma_f32_16x16x32_bf16 v[240:243], v[48:51], v[140:143], v[240:243]
  s_waitcnt vmcnt(32) lgkmcnt(0)
  v_mfma_f32_16x16x32_bf16 v[224:227], v[32:35], v[144:147], v[224:227]
  ds_read_b64_tr_b16 v[48:49], v8 offset:45056
  ds_read_b64_tr_b16 v[50:51], v8 offset:47104
  v_mfma_f32_16x16x32_bf16 v[228:231], v[36:39], v[144:147], v[228:231]
  ds_read_b64_tr_b16 v[52:53], v9 offset:45056
  ds_read_b64_tr_b16 v[54:55], v9 offset:47104
  buffer_load_dwordx4 v[104:107], v3, s[8:11], s26 offen offset:1024 sc1
  v_mfma_f32_16x16x32_bf16 v[232:235], v[40:43], v[144:147], v[232:235]
  ds_read_b64_tr_b16 v[56:57], v10 offset:45056
  ds_read_b64_tr_b16 v[58:59], v10 offset:47104
  v_mfma_f32_16x16x32_bf16 v[236:239], v[44:47], v[144:147], v[236:239]
  ds_read_b64_tr_b16 v[60:61], v11 offset:45056
  ds_read_b64_tr_b16 v[62:63], v11 offset:47104
  buffer_load_dwordx4 v[108:111], v20, s[8:11], s26 offen offset:1024 sc1
  v_mfma_f32_16x16x32_bf16 v[252:255], v[44:47], v[148:151], v[252:255]
  v_mfma_f32_16x16x32_bf16 v[248:251], v[40:43], v[148:151], v[248:251]
  v_mfma_f32_16x16x32_bf16 v[244:247], v[36:39], v[148:151], v[244:247]
  buffer_load_dwordx4 v[112:115], v3, s[8:11], s26 offen offset:2048 sc1
  v_mfma_f32_16x16x32_bf16 v[240:243], v[32:35], v[148:151], v[240:243]
  s_waitcnt vmcnt(29) lgkmcnt(0)
  s_barrier
  v_mfma_f32_16x16x32_bf16 v[224:227], v[48:51], v[152:155], v[224:227]
  ds_read_b64_tr_b16 v[32:33], v8 offset:49152
  ds_read_b64_tr_b16 v[34:35], v8 offset:51200
  v_mfma_f32_16x16x32_bf16 v[228:231], v[52:55], v[152:155], v[228:231]
  ds_read_b64_tr_b16 v[36:37], v9 offset:49152
  ds_read_b64_tr_b16 v[38:39], v9 offset:51200
  buffer_load_dwordx4 v[116:119], v20, s[8:11], s26 offen offset:2048 sc1
  v_mfma_f32_16x16x32_bf16 v[232:235], v[56:59], v[152:155], v[232:235]
  ds_read_b64_tr_b16 v[40:41], v10 offset:49152
  ds_read_b64_tr_b16 v[42:43], v10 offset:51200
  v_mfma_f32_16x16x32_bf16 v[236:239], v[60:63], v[152:155], v[236:239]
  ds_read_b64_tr_b16 v[44:45], v11 offset:49152
  ds_read_b64_tr_b16 v[46:47], v11 offset:51200
  buffer_load_dwordx4 v[120:123], v3, s[8:11], s26 offen offset:3072 sc1
  v_mfma_f32_16x16x32_bf16 v[252:255], v[60:63], v[156:159], v[252:255]
  v_mfma_f32_16x16x32_bf16 v[248:251], v[56:59], v[156:159], v[248:251]
  v_mfma_f32_16x16x32_bf16 v[244:247], v[52:55], v[156:159], v[244:247]
  buffer_load_dwordx4 v[124:127], v20, s[8:11], s26 offen offset:3072 sc1
  s_add_u32 s26, s26, 4096
  v_mfma_f32_16x16x32_bf16 v[240:243], v[48:51], v[156:159], v[240:243]
  s_waitcnt vmcnt(30) lgkmcnt(0)
  v_mfma_f32_16x16x32_bf16 v[224:227], v[32:35], v[160:163], v[224:227]
  ds_read_b64_tr_b16 v[48:49], v8 offset:53248
  ds_read_b64_tr_b16 v[50:51], v8 offset:55296
  s_add_u32 m0, s29, 32768
  v_mfma_f32_16x16x32_bf16 v[228:231], v[36:39], v[160:163], v[228:231]
  ds_read_b64_tr_b16 v[52:53], v9 offset:53248
  ds_read_b64_tr_b16 v[54:55], v9 offset:55296
  buffer_load_dwordx4 v4, s[12:15], s28 offen lds
  v_mfma_f32_16x16x32_bf16 v[232:235], v[40:43], v[160:163], v[232:235]
  ds_read_b64_tr_b16 v[56:57], v10 offset:53248
  ds_read_b64_tr_b16 v[58:59], v10 offset:55296
  s_add_u32 m0, s29, 33792
  v_mfma_f32_16x16x32_bf16 v[236:239], v[44:47], v[160:163], v[236:239]
  ds_read_b64_tr_b16 v[60:61], v11 offset:53248
  ds_read_b64_tr_b16 v[62:63], v11 offset:55296
  buffer_load_dwordx4 v5, s[12:15], s28 offen lds
  v_mfma_f32_16x16x32_bf16 v[252:255], v[44:47], v[164:167], v[252:255]
  v_mfma_f32_16x16x32_bf16 v[248:251], v[40:43], v[164:167], v[248:251]
  s_add_u32 m0, s29, 34816
  v_mfma_f32_16x16x32_bf16 v[244:247], v[36:39], v[164:167], v[244:247]
  buffer_load_dwordx4 v6, s[12:15], s28 offen lds
  v_mfma_f32_16x16x32_bf16 v[240:243], v[32:35], v[164:167], v[240:243]
  s_waitcnt vmcnt(31) lgkmcnt(0)
  v_mfma_f32_16x16x32_bf16 v[224:227], v[48:51], v[168:171], v[224:227]
  ds_read_b64_tr_b16 v[32:33], v8 offset:57344
  ds_read_b64_tr_b16 v[34:35], v8 offset:59392
  s_add_u32 m0, s29, 35840
  v_mfma_f32_16x16x32_bf16 v[228:231], v[52:55], v[168:171], v[228:231]
  ds_read_b64_tr_b16 v[36:37], v9 offset:57344
  ds_read_b64_tr_b16 v[38:39], v9 offset:59392
  buffer_load_dwordx4 v7, s[12:15], s28 offen lds
  s_add_u32 s28, s28, 262144
  v_mfma_f32_16x16x32_bf16 v[232:235], v[56:59], v[168:171], v[232:235]
  ds_read_b64_tr_b16 v[40:41], v10 offset:57344
  ds_read_b64_tr_b16 v[42:43], v10 offset:59392
  v_mfma_f32_16x16x32_bf16 v[236:239], v[60:63], v[168:171], v[236:239]
  ds_read_b64_tr_b16 v[44:45], v11 offset:57344
  ds_read_b64_tr_b16 v[46:47], v11 offset:59392
  buffer_load_dwordx4 v[128:131], v3, s[8:11], s26 offen offset:0 sc1
  v_mfma_f32_16x16x32_bf16 v[252:255], v[60:63], v[172:175], v[252:255]
  v_mfma_f32_16x16x32_bf16 v[248:251], v[56:59], v[172:175], v[248:251]
  v_mfma_f32_16x16x32_bf16 v[244:247], v[52:55], v[172:175], v[244:247]
  buffer_load_dwordx4 v[132:135], v20, s[8:11], s26 offen offset:0 sc1
  v_mfma_f32_16x16x32_bf16 v[240:243], v[48:51], v[172:175], v[240:243]
  s_waitcnt vmcnt(32) lgkmcnt(0)
  v_mfma_f32_16x16x32_bf16 v[224:227], v[32:35], v[176:179], v[224:227]
  ds_read_b64_tr_b16 v[48:49], v8 offset:61440
  ds_read_b64_tr_b16 v[50:51], v8 offset:63488
  v_mfma_f32_16x16x32_bf16 v[228:231], v[36:39], v[176:179], v[228:231]
  ds_read_b64_tr_b16 v[52:53], v9 offset:61440
  ds_read_b64_tr_b16 v[54:55], v9 offset:63488
  buffer_load_dwordx4 v[136:139], v3, s[8:11], s26 offen offset:1024 sc1
  v_mfma_f32_16x16x32_bf16 v[232:235], v[40:43], v[176:179], v[232:235]
  ds_read_b64_tr_b16 v[56:57], v10 offset:61440
  ds_read_b64_tr_b16 v[58:59], v10 offset:63488
  v_mfma_f32_16x16x32_bf16 v[236:239], v[44:47], v[176:179], v[236:239]
  ds_read_b64_tr_b16 v[60:61], v11 offset:61440
  ds_read_b64_tr_b16 v[62:63], v11 offset:63488
  buffer_load_dwordx4 v[140:143], v20, s[8:11], s26 offen offset:1024 sc1
  v_mfma_f32_16x16x32_bf16 v[252:255], v[44:47], v[180:183], v[252:255]
  v_mfma_f32_16x16x32_bf16 v[248:251], v[40:43], v[180:183], v[248:251]
  v_mfma_f32_16x16x32_bf16 v[244:247], v[36:39], v[180:183], v[244:247]
  buffer_load_dwordx4 v[144:147], v3, s[8:11], s26 offen offset:2048 sc1
  v_mfma_f32_16x16x32_bf16 v[240:243], v[32:35], v[180:183], v[240:243]
  s_waitcnt vmcnt(29) lgkmcnt(0)
  s_barrier
  v_mfma_f32_16x16x32_bf16 v[224:227], v[48:51], v[184:187], v[224:227]
  ds_read_b64_tr_b16 v[32:33], v8 offset:0
  ds_read_b64_tr_b16 v[34:35], v8 offset:2048
  v_mfma_f32_16x16x32_bf16 v[228:231], v[52:55], v[184:187], v[228:231]
  ds_read_b64_tr_b16 v[36:37], v9 offset:0
  ds_read_b64_tr_b16 v[38:39], v9 offset:2048
  buffer_load_dwordx4 v[148:151], v20, s[8:11], s26 offen offset:2048 sc1
  v_mfma_f32_16x16x32_bf16 v[232:235], v[56:59], v[184:187], v[232:235]
  ds_read_b64_tr_b16 v[40:41], v10 offset:0
  ds_read_b64_tr_b16 v[42:43], v10 offset:2048
  v_mfma_f32_16x16x32_bf16 v[236:239], v[60:63], v[184:187], v[236:239]
  ds_read_b64_tr_b16 v[44:45], v11 offset:0
  ds_read_b64_tr_b16 v[46:47], v11 offset:2048
  buffer_load_dwordx4 v[152:155], v3, s[8:11], s26 offen offset:3072 sc1
  v_mfma_f32_16x16x32_bf16 v[252:255], v[60:63], v[188:191], v[252:255]
  v_mfma_f32_16x16x32_bf16 v[248:251], v[56:59], v[188:191], v[248:251]
  v_mfma_f32_16x16x32_bf16 v[244:247], v[52:55], v[188:191], v[244:247]
  buffer_load_dwordx4 v[156:159], v20, s[8:11], s26 offen offset:3072 sc1
  s_add_u32 s26, s26, 4096
  v_mfma_f32_16x16x32_bf16 v[240:243], v[48:51], v[188:191], v[240:243]
  s_sub_u32 s47, s47, 1
  s_cmp_lg_u32 s47, 0
  s_cbranch_scc1 k2_loop
  s_waitcnt vmcnt(30) lgkmcnt(0)
  v_mfma_f32_16x16x32_bf16 v[224:227], v[32:35], v[64:67], v[224:227]
  ds_read_b64_tr_b16 v[48:49], v8 offset:4096
  ds_read_b64_tr_b16 v[50:51], v8 offset:6144
  s_add_u32 m0, s29, 49152
  v_mfma_f32_16x16x32_bf16 v[228:231], v[36:39], v[64:67], v[228:231]
  ds_read_b64_tr_b16 v[52:53], v9 offset:4096
  ds_read_b64_tr_b16 v[54:55], v9 offset:6144
  buffer_load_dwordx4 v4, s[12:15], s28 offen lds
  v_mfma_f32_16x16x32_bf16 v[232:235], v[40:43], v[64:67], v[232:235]
  ds_read_b64_tr_b16 v[56:57], v10 offset:4096
  ds_read_b64_tr_b16 v[58:59], v10 offset:6144
  s_add_u32 m0, s29, 50176
  v_mfma_f32_16x16x32_bf16 v[236:239], v[44:47], v[64:67], v[236:239]
  ds_read_b64_tr_b16 v[60:61], v11 offset:4096
  ds_read_b64_tr_b16 v[62:63], v11 offset:6144
  buffer_load_dwordx4 v5, s[12:15], s28 offen lds
  v_mfma_f32_16x16x32_bf16 v[252:255], v[44:47], v[68:71], v[252:255]
  v_mfma_f32_16x16x32_bf16 v[248:251], v[40:43], v[68:71], v[248:251]
  s_add_u32 m0, s29, 51200
  v_mfma_f32_16x16x32_bf16 v[244:247], v[36:39], v[68:71], v[244:247]
  buffer_load_dwordx4 v6, s[12:15], s28 offen lds
  v_mfma_f32_16x16x32_bf16 v[240:243], v[32:35], v[68:71], v[240:243]
  s_waitcnt vmcnt(31) lgkmcnt(0)
  v_mfma_f32_16x16x32_bf16 v[224:227], v[48:51], v[72:75], v[224:227]
  ds_read_b64_tr_b16 v[32:33], v8 offset:8192
  ds_read_b64_tr_b16 v[34:35], v8 offset:10240
  s_add_u32 m0, s29, 52224
  v_mfma_f32_16x16x32_bf16 v[228:231], v[52:55], v[72:75], v[228:231]
  ds_read_b64_tr_b16 v[36:37], v9 offset:8192
  ds_read_b64_tr_b16 v[38:39], v9 offset:10240
  buffer_load_dwordx4 v7, s[12:15], s28 offen lds
  s_add_u32 s28, s28, 262144
  v_mfma_f32_16x16x32_bf16 v[232:235], v[56:59], v[72:75], v[232:235]
  ds_read_b64_tr_b16 v[40:41], v10 offset:8192
  ds_read_b64_tr_b16 v[42:43], v10 offset:10240
  v_mfma_f32_16x16x32_bf16 v[236:239], v[60:63], v[72:75], v[236:239]
  ds_read_b64_tr_b16 v[44:45], v11 offset:8192
  ds_read_b64_tr_b16 v[46:47], v11 offset:10240
  buffer_load_dwordx4 v[160:163], v3, s[8:11], s26 offen offset:0 sc1
  v_mfma_f32_16x16x32_bf16 v[252:255], v[60:63], v[76:79], v[252:255]
  v_mfma_f32_16x16x32_bf16 v[248:251], v[56:59], v[76:79], v[248:251]
  v_mfma_f32_16x16x32_bf16 v[244:247], v[52:55], v[76:79], v[244:247]
  buffer_load_dwordx4 v[164:167], v20, s[8:11], s26 offen offset:0 sc1
  v_mfma_f32_16x16x32_bf16 v[240:243], v[48:51], v[76:79], v[240:243]
  s_waitcnt vmcnt(32) lgkmcnt(0)
  v_mfma_f32_16x16x32_bf16 v[224:227], v[32:35], v[80:83], v[224:227]
  ds_read_b64_tr_b16 v[48:49], v8 offset:12288
  ds_read_b64_tr_b16 v[50:51], v8 offset:14336
  v_mfma_f32_16x16x32_bf16 v[228:231], v[36:39], v[80:83], v[228:231]
  ds_read_b64_tr_b16 v[52:53], v9 offset:12288
  ds_read_b64_tr_b16 v[54:55], v9 offset:14336
  buffer_load_dwordx4 v[168:171], v3, s[8:11], s26 offen offset:1024 sc1
  v_mfma_f32_16x16x32_bf16 v[232:235], v[40:43], v[80:83], v[232:235]
  ds_read_b64_tr_b16 v[56:57], v10 offset:12288
  ds_read_b64_tr_b16 v[58:59], v10 offset:14336
  v_mfma_f32_16x16x32_bf16 v[236:239], v[44:47], v[80:83], v[236:239]
  ds_read_b64_tr_b16 v[60:61], v11 offset:12288
  ds_read_b64_tr_b16 v[62:63], v11 offset:14336
  buffer_load_dwordx4 v[172:175], v20, s[8:11], s26 offen offset:1024 sc1
  v_mfma_f32_16x16x32_bf16 v[252:255], v[44:47], v[84:87], v[252:255]
  v_mfma_f32_16x16x32_bf16 v[248:251], v[40:43], v[84:87], v[248:251]
  v_mfma_f32_16x16x32_bf16 v[244:247], v[36:39], v[84:87], v[244:247]
  buffer_load_dwordx4 v[176:179], v3, s[8:11], s26 offen offset:2048 sc1
  v_mfma_f32_16x16x32_bf16 v[240:243], v[32:35], v[84:87], v[240:243]
  s_waitcnt vmcnt(29) lgkmcnt(0)
  s_barrier
  v_mfma_f32_16x16x32_bf16 v[224:227], v[48:51], v[88:91], v[224:227]
  ds_read_b64_tr_b16 v[32:33], v8 offset:16384
  ds_read_b64_tr_b16 v[34:35], v8 offset:18432
  v_mfma_f32_16x16x32_bf16 v[228:231], v[52:55], v[88:91], v[228:231]
  ds_read_b64_tr_b16 v[36:37], v9 offset:16384
  ds_read_b64_tr_b16 v[38:39], v9 offset:18432
  buffer_load_dwordx4 v[180:183], v20, s[8:11], s26 offen offset:2048 sc1
  v_mfma_f32_16x16x32_bf16 v[232:235], v[56:59], v[88:91], v[232:235]
  ds_read_b64_tr_b16 v[40:41], v10 offset:16384
  ds_read_b64_tr_b16 v[42:43], v10 offset:18432
  v_mfma_f32_16x16x32_bf16 v[236:239], v[60:63], v[88:91], v[236:239]
  ds_read_b64_tr_b16 v[44:45], v11 offset:16384
  ds_read_b64_tr_b16 v[46:47], v11 offset:18432
  buffer_load_dwordx4 v[184:187], v3, s[8:11], s26 offen offset:3072 sc1
  v_mfma_f32_16x16x32_bf16 v[252:255], v[60:63], v[92:95], v[252:255]
  v_mfma_f32_16x16x32_bf16 v[248:251], v[56:59], v[92:95], v[248:251]
  v_mfma_f32_16x16x32_bf16 v[244:247], v[52:55], v[92:95], v[244:247]
  buffer_load_dwordx4 v[188:191], v20, s[8:11], s26 offen offset:3072 sc1
  s_add_u32 s26, s26, 4096
  v_mfma_f32_16x16x32_bf16 v[240:243], v[48:51], v[92:95], v[240:243]
  s_waitcnt vmcnt(30) lgkmcnt(0)
  v_mfma_f32_16x16x32_bf16 v[224:227], v[32:35], v[96:99], v[224:227]
  ds_read_b64_tr_b16 v[48:49], v8 offset:20480
  ds_read_b64_tr_b16 v[50:51], v8 offset:22528
  v_mfma_f32_16x16x32_bf16 v[228:231], v[36:39], v[96:99], v[228:231]
  ds_read_b64_tr_b16 v[52:53], v9 offset:20480
  ds_read_b64_tr_b16 v[54:55], v9 offset:22528
  buffer_load_dword v17, v15, s[92:95], s45 offen sc1
  v_mfma_f32_16x16x32_bf16 v[232:235], v[40:43], v[96:99], v[232:235]
  ds_read_b64_tr_b16 v[56:57], v10 offset:20480
  ds_read_b64_tr_b16 v[58:59], v10 offset:22528
  v_mfma_f32_16x16x32_bf16 v[236:239], v[44:47], v[96:99], v[236:239]
  ds_read_b64_tr_b16 v[60:61], v11 offset:20480
  ds_read_b64_tr_b16 v[62:63], v11 offset:22528
  buffer_load_dwordx4 v[192:195], v12, s[16:19], s30 offen offset:0
  v_mfma_f32_16x16x32_bf16 v[252:255], v[44:47], v[100:103], v[252:255]
  v_mfma_f32_16x16x32_bf16 v[248:251], v[40:43], v[100:103], v[248:251]
  v_mfma_f32_16x16x32_bf16 v[244:247], v[36:39], v[100:103], v[244:247]
  buffer_load_dwordx4 v[196:199], v12, s[16:19], s30 offen offset:64
  v_mfma_f32_16x16x32_bf16 v[240:243], v[32:35], v[100:103], v[240:243]
  s_waitcnt vmcnt(31) lgkmcnt(0)
  v_mfma_f32_16x16x32_bf16 v[224:227], v[48:51], v[104:107], v[224:227]
  ds_read_b64_tr_b16 v[32:33], v8 offset:24576
  ds_read_b64_tr_b16 v[34:35], v8 offset:26624
  v_mfma_f32_16x16x32_bf16 v[228:231], v[52:55], v[104:107], v[228:231]
  ds_read_b64_tr_b16 v[36:37], v9 offset:24576
  ds_read_b64_tr_b16 v[38:39], v9 offset:26624
  buffer_load_dwordx4 v[200:203], v13, s[16:19], s30 offen offset:0
  v_mfma_f32_16x16x32_bf16 v[232:235], v[56:59], v[104:107], v[232:235]
  ds_read_b64_tr_b16 v[40:41], v10 offset:24576
  ds_read_b64_tr_b16 v[42:43], v10 offset:26624
  v_mfma_f32_16x16x32_bf16 v[236:239], v[60:63], v[104:107], v[236:239]
  ds_read_b64_tr_b16 v[44:45], v11 offset:24576
  ds_read_b64_tr_b16 v[46:47], v11 offset:26624
  buffer_load_dwordx4 v[204:207], v13, s[16:19], s30 offen offset:64
  v_mfma_f32_16x16x32_bf16 v[252:255], v[60:63], v[108:111], v[252:255]
  v_mfma_f32_16x16x32_bf16 v[248:251], v[56:59], v[108:111], v[248:251]
  v_mfma_f32_16x16x32_bf16 v[244:247], v[52:55], v[108:111], v[244:247]
  v_mfma_f32_16x16x32_bf16 v[240:243], v[48:51], v[108:111], v[240:243]
  s_waitcnt vmcnt(31) lgkmcnt(0)
  v_mfma_f32_16x16x32_bf16 v[224:227], v[32:35], v[112:115], v[224:227]
  ds_read_b64_tr_b16 v[48:49], v8 offset:28672
  ds_read_b64_tr_b16 v[50:51], v8 offset:30720
  v_mfma_f32_16x16x32_bf16 v[228:231], v[36:39], v[112:115], v[228:231]
  ds_read_b64_tr_b16 v[52:53], v9 offset:28672
  ds_read_b64_tr_b16 v[54:55], v9 offset:30720
  v_mfma_f32_16x16x32_bf16 v[232:235], v[40:43], v[112:115], v[232:235]
  ds_read_b64_tr_b16 v[56:57], v10 offset:28672
  ds_read_b64_tr_b16 v[58:59], v10 offset:30720
  v_mfma_f32_16x16x32_bf16 v[236:239], v[44:47], v[112:115], v[236:239]
  ds_read_b64_tr_b16 v[60:61], v11 offset:28672
  ds_read_b64_tr_b16 v[62:63], v11 offset:30720
  v_mfma_f32_16x16x32_bf16 v[252:255], v[44:47], v[116:119], v[252:255]
  v_mfma_f32_16x16x32_bf16 v[248:251], v[40:43], v[116:119], v[248:251]
  v_mfma_f32_16x16x32_bf16 v[244:247], v[36:39], v[116:119], v[244:247]
  v_mfma_f32_16x16x32_bf16 v[240:243], v[32:35], v[116:119], v[240:243]
  s_waitcnt vmcnt(25) lgkmcnt(0)
  s_barrier
  v_mfma_f32_16x16x32_bf16 v[224:227], v[48:51], v[120:123], v[224:227]
  ds_read_b64_tr_b16 v[32:33], v8 offset:32768
  ds_read_b64_tr_b16 v[34:35], v8 offset:34816
  v_mfma_f32_16x16x32_bf16 v[228:231], v[52:55], v[120:123], v[228:231]
  ds_read_b64_tr_b16 v[36:37], v9 offset:32768
  ds_read_b64_tr_b16 v[38:39], v9 offset:34816
  v_mfma_f32_16x16x32_bf16 v[232:235], v[56:59], v[120:123], v[232:235]
  ds_read_b64_tr_b16 v[40:41], v10 offset:32768
  ds_read_b64_tr_b16 v[42:43], v10 offset:34816
  v_mfma_f32_16x16x32_bf16 v[236:239], v[60:63], v[120:123], v[236:239]
  ds_read_b64_tr_b16 v[44:45], v11 offset:32768
  ds_read_b64_tr_b16 v[46:47], v11 offset:34816
  v_mfma_f32_16x16x32_bf16 v[252:255], v[60:63], v[124:127], v[252:255]
  v_mfma_f32_16x16x32_bf16 v[248:251], v[56:59], v[124:127], v[248:251]
  v_mfma_f32_16x16x32_bf16 v[244:247], v[52:55], v[124:127], v[244:247]
  v_mfma_f32_16x16x32_bf16 v[240:243], v[48:51], v[124:127], v[240:243]
  s_waitcnt vmcnt(4)
  v_cmp_ne_u32 vcc, s88, v17
  s_nop 4
  s_cbranch_vccz k2_q_ok
  v_lshlrev_b32 v15, 2, v2
  s_mov_b64 exec, -1
k2_q:
  buffer_load_dword v14, v15, s[92:95], s45 offen sc1
  s_waitcnt vmcnt(0)
  v_cmp_ne_u32 vcc, s88, v14
  s_nop 4
  s_cbranch_vccnz k2_q
k2_q_ok:
  s_mov_b64 exec, -1
  s_waitcnt vmcnt(23) lgkmcnt(0)
  v_mfma_f32_16x16x32_bf16 v[224:227], v[32:35], v[128:131], v[224:227]
  ds_read_b64_tr_b16 v[48:49], v8 offset:36864
  ds_read_b64_tr_b16 v[50:51], v8 offset:38912
  v_mfma_f32_16x16x32_bf16 v[228:231], v[36:39], v[128:131], v[228:231]
  ds_read_b64_tr_b16 v[52:53], v9 offset:36864
  ds_read_b64_tr_b16 v[54:55], v9 offset:38912
  buffer_load_dwordx4 v[208:211], v12, s[32:35], s30 offen offset:0 sc1
  v_mfma_f32_16x16x32_bf16 v[232:235], v[40:43], v[128:131], v[232:235]
  ds_read_b64_tr_b16 v[56:57], v10 offset:36864
  ds_read_b64_tr_b16 v[58:59], v10 offset:38912
  v_mfma_f32_16x16x32_bf16 v[236:239], v[44:47], v[128:131], v[236:239]
  ds_read_b64_tr_b16 v[60:61], v11 offset:36864
  ds_read_b64_tr_b16 v[62:63], v11 offset:38912
  buffer_load_dwordx4 v[212:215], v12, s[32:35], s30 offen offset:64 sc1
  v_mfma_f32_16x16x32_bf16 v[252:255], v[44:47], v[132:135], v[252:255]
  v_mfma_f32_16x16x32_bf16 v[248:251], v[40:43], v[132:135], v[248:251]
  v_mfma_f32_16x16x32_bf16 v[244:247], v[36:39], v[132:135], v[244:247]
  buffer_load_dwordx4 v[216:219], v13, s[32:35], s30 offen offset:0 sc1
  v_mfma_f32_16x16x32_bf16 v[240:243], v[32:35], v[132:135], v[240:243]
  s_waitcnt vmcnt(24) lgkmcnt(0)
  v_mfma_f32_16x16x32_bf16 v[224:227], v[48:51], v[136:139], v[224:227]
  ds_read_b64_tr_b16 v[32:33], v8 offset:40960
  ds_read_b64_tr_b16 v[34:35], v8 offset:43008
  v_mfma_f32_16x16x32_bf16 v[228:231], v[52:55], v[136:139], v[228:231]
  ds_read_b64_tr_b16 v[36:37], v9 offset:40960
  ds_read_b64_tr_b16 v[38:39], v9 offset:43008
  buffer_load_dwordx4 v[220:223], v13, s[32:35], s30 offen offset:64 sc1
  v_mfma_f32_16x16x32_bf16 v[232:235], v[56:59], v[136:139], v[232:235]
  ds_read_b64_tr_b16 v[40:41], v10 offset:40960
  ds_read_b64_tr_b16 v[42:43], v10 offset:43008
  v_mfma_f32_16x16x32_bf16 v[236:239], v[60:63], v[136:139], v[236:239]
  ds_read_b64_tr_b16 v[44:45], v11 offset:40960
  ds_read_b64_tr_b16 v[46:47], v11 offset:43008
  v_mfma_f32_16x16x32_bf16 v[252:255], v[60:63], v[140:143], v[252:255]
  v_mfma_f32_16x16x32_bf16 v[248:251], v[56:59], v[140:143], v[248:251]
  v_mfma_f32_16x16x32_bf16 v[244:247], v[52:55], v[140:143], v[244:247]
  v_mfma_f32_16x16x32_bf16 v[240:243], v[48:51], v[140:143], v[240:243]
  s_waitcnt vmcnt(23) lgkmcnt(0)
  v_mfma_f32_16x16x32_bf16 v[224:227], v[32:35], v[144:147], v[224:227]
  ds_read_b64_tr_b16 v[48:49], v8 offset:45056
  ds_read_b64_tr_b16 v[50:51], v8 offset:47104
  v_mfma_f32_16x16x32_bf16 v[228:231], v[36:39], v[144:147], v[228:231]
  ds_read_b64_tr_b16 v[52:53], v9 offset:45056
  ds_read_b64_tr_b16 v[54:55], v9 offset:47104
  v_mfma_f32_16x16x32_bf16 v[232:235], v[40:43], v[144:147], v[232:235]
  ds_read_b64_tr_b16 v[56:57], v10 offset:45056
  ds_read_b64_tr_b16 v[58:59], v10 offset:47104
  v_mfma_f32_16x16x32_bf16 v[236:239], v[44:47], v[144:147], v[236:239]
  ds_read_b64_tr_b16 v[60:61], v11 offset:45056
  ds_read_b64_tr_b16 v[62:63], v11 offset:47104
  v_mfma_f32_16x16x32_bf16 v[252:255], v[44:47], v[148:151], v[252:255]
  v_mfma_f32_16x16x32_bf16 v[248:251], v[40:43], v[148:151], v[248:251]
  v_mfma_f32_16x16x32_bf16 v[244:247], v[36:39], v[148:151], v[244:247]
  v_mfma_f32_16x16x32_bf16 v[240:243], v[32:35], v[148:151], v[240:243]
  s_waitcnt vmcnt(17) lgkmcnt(0)
  s_barrier
  v_mfma_f32_16x16x32_bf16 v[224:227], v[48:51], v[152:155], v[224:227]
  ds_read_b64_tr_b16 v[32:33], v8 offset:49152
  ds_read_b64_tr_b16 v[34:35], v8 offset:51200
  v_mfma_f32_16x16x32_bf16 v[228:231], v[52:55], v[152:155], v[228:231]
  ds_read_b64_tr_b16 v[36:37], v9 offset:49152
  ds_read_b64_tr_b16 v[38:39], v9 offset:51200
  v_mfma_f32_16x16x32_bf16 v[232:235], v[56:59], v[152:155], v[232:235]
  ds_read_b64_tr_b16 v[40:41], v10 offset:49152
  ds_read_b64_tr_b16 v[42:43], v10 offset:51200
  v_mfma_f32_16x16x32_bf16 v[236:239], v[60:63], v[152:155], v[236:239]
  ds_read_b64_tr_b16 v[44:45], v11 offset:49152
  ds_read_b64_tr_b16 v[46:47], v11 offset:51200
  v_mfma_f32_16x16x32_bf16 v[252:255], v[60:63], v[156:159], v[252:255]
  v_mfma_f32_16x16x32_bf16 v[248:251], v[56:59], v[156:159], v[248:251]
  v_mfma_f32_16x16x32_bf16 v[244:247], v[52:55], v[156:159], v[244:247]
  v_mfma_f32_16x16x32_bf16 v[240:243], v[48:51], v[156:159], v[240:243]
  s_waitcnt vmcnt(15) lgkmcnt(0)
  v_mfma_f32_16x16x32_bf16 v[224:227], v[32:35], v[160:163], v[224:227]
  ds_read_b64_tr_b16 v[48:49], v8 offset:53248
  ds_read_b64_tr_b16 v[50:51], v8 offset:55296
  v_mfma_f32_16x16x32_bf16 v[228:231], v[36:39], v[160:163], v[228:231]
  ds_read_b64_tr_b16 v[52:53], v9 offset:53248
  ds_read_b64_tr_b16 v[54:55], v9 offset:55296
  v_mfma_f32_16x16x32_bf16 v[232:235], v[40:43], v[160:163], v[232:235]
  ds_read_b64_tr_b16 v[56:57], v10 offset:53248
  ds_read_b64_tr_b16 v[58:59], v10 offset:55296
  v_mfma_f32_16x16x32_bf16 v[236:239], v[44:47], v[160:163], v[236:239]
  ds_read_b64_tr_b16 v[60:61], v11 offset:53248
  ds_read_b64_tr_b16 v[62:63], v11 offset:55296
  v_mfma_f32_16x16x32_bf16 v[252:255], v[44:47], v[164:167], v[252:255]
  v_mfma_f32_16x16x32_bf16 v[248:251], v[40:43], v[164:167], v[248:251]
  v_mfma_f32_16x16x32_bf16 v[244:247], v[36:39], v[164:167], v[244:247]
  v_mfma_f32_16x16x32_bf16 v[240:243], v[32:35], v[164:167], v[240:243]
  s_waitcnt vmcnt(13) lgkmcnt(0)
  v_mfma_f32_16x16x32_bf16 v[224:227], v[48:51], v[168:171], v[224:227]
  ds_read_b64_tr_b16 v[32:33], v8 offset:57344
  ds_read_b64_tr_b16 v[34:35], v8 offset:59392
  v_mfma_f32_16x16x32_bf16 v[228:231], v[52:55], v[168:171], v[228:231]
  ds_read_b64_tr_b16 v[36:37], v9 offset:57344
  ds_read_b64_tr_b16 v[38:39], v9 offset:59392
  v_mfma_f32_16x16x32_bf16 v[232:235], v[56:59], v[168:171], v[232:235]
  ds_read_b64_tr_b16 v[40:41], v10 offset:57344
  ds_read_b64_tr_b16 v[42:43], v10 offset:59392
  v_mfma_f32_16x16x32_bf16 v[236:239], v[60:63], v[168:171], v[236:239]
  ds_read_b64_tr_b16 v[44:45], v11 offset:57344
  ds_read_b64_tr_b16 v[46:47], v11 offset:59392
  v_mfma_f32_16x16x32_bf16 v[252:255], v[60:63], v[172:175], v[252:255]
  v_mfma_f32_16x16x32_bf16 v[248:251], v[56:59], v[172:175], v[248:251]
  v_mfma_f32_16x16x32_bf16 v[244:247], v[52:55], v[172:175], v[244:247]
  v_mfma_f32_16x16x32_bf16 v[240:243], v[48:51], v[172:175], v[240:243]
  s_waitcnt vmcnt(11) lgkmcnt(0)
  v_mfma_f32_16x16x32_bf16 v[224:227], v[32:35], v[176:179], v[224:227]
  ds_read_b64_tr_b16 v[48:49], v8 offset:61440
  ds_read_b64_tr_b16 v[50:51], v8 offset:63488
  v_mfma_f32_16x16x32_bf16 v[228:231], v[36:39], v[176:179], v[228:231]
  ds_read_b64_tr_b16 v[52:53], v9 offset:61440
  ds_read_b64_tr_b16 v[54:55], v9 offset:63488
  v_mfma_f32_16x16x32_bf16 v[232:235], v[40:43], v[176:179], v[232:235]
  ds_read_b64_tr_b16 v[56:57], v10 offset:61440
  ds_read_b64_tr_b16 v[58:59], v10 offset:63488
  v_mfma_f32_16x16x32_bf16 v[236:239], v[44:47], v[176:179], v[236:239]
  ds_read_b64_tr_b16 v[60:61], v11 offset:61440
  ds_read_b64_tr_b16 v[62:63], v11 offset:63488
  v_mfma_f32_16x16x32_bf16 v[252:255], v[44:47], v[180:183], v[252:255]
  v_mfma_f32_16x16x32_bf16 v[248:251], v[40:43], v[180:183], v[248:251]
  v_mfma_f32_16x16x32_bf16 v[244:247], v[36:39], v[180:183], v[244:247]
  v_mfma_f32_16x16x32_bf16 v[240:243], v[32:35], v[180:183], v[240:243]
  s_waitcnt vmcnt(9) lgkmcnt(0)
  v_mfma_f32_16x16x32_bf16 v[224:227], v[48:51], v[184:187], v[224:227]
  v_mfma_f32_16x16x32_bf16 v[228:231], v[52:55], v[184:187], v[228:231]
  v_mfma_f32_16x16x32_bf16 v[232:235], v[56:59], v[184:187], v[232:235]
  v_mfma_f32_16x16x32_bf16 v[236:239], v[60:63], v[184:187], v[236:239]
  v_mfma_f32_16x16x32_bf16 v[252:255], v[60:63], v[188:191], v[252:255]
  v_mfma_f32_16x16x32_bf16 v[248:251], v[56:59], v[188:191], v[248:251]
  v_mfma_f32_16x16x32_bf16 v[244:247], v[52:55], v[188:191], v[244:247]
  v_mfma_f32_16x16x32_bf16 v[240:243], v[48:51], v[188:191], v[240:243]
  v_mov_b32 v128, 0xbfb8aa3b
  v_mov_b32 v129, 0xbfb8aa3b
  v_mov_b32 v130, 1.0
  v_mov_b32 v131, 1.0
  v_pk_mul_f32 v[96:97], v[128:129], v[224:225]
  v_pk_mul_f32 v[98:99], v[128:129], v[226:227]
  v_pk_mul_f32 v[100:101], v[128:129], v[228:229]
  v_pk_mul_f32 v[102:103], v[128:129], v[230:231]
  v_pk_mul_f32 v[104:105], v[128:129], v[232:233]
  v_pk_mul_f32 v[106:107], v[128:129], v[234:235]
  v_pk_mul_f32 v[108:109], v[128:129], v[236:237]
  v_pk_mul_f32 v[110:111], v[128:129], v[238:239]
  v_pk_mul_f32 v[112:113], v[128:129], v[240:241]
  v_pk_mul_f32 v[114:115], v[128:129], v[242:243]
  v_pk_mul_f32 v[116:117], v[128:129], v[244:245]
  v_pk_mul_f32 v[118:119], v[128:129], v[246:247]
  v_pk_mul_f32 v[120:121], v[128:129], v[248:249]
  v_pk_mul_f32 v[122:123], v[128:129], v[250:251]
  v_pk_mul_f32 v[124:125], v[128:129], v[252:253]
  v_pk_mul_f32 v[126:127], v[128:129], v[254:255]
  v_exp_f32 v96, v96
  v_exp_f32 v97, v97
  v_exp_f32 v98, v98
  v_exp_f32 v99, v99
  v_exp_f32 v100, v100
  v_exp_f32 v101, v101
  v_exp_f32 v102, v102
  v_exp_f32 v103, v103
  v_exp_f32 v104, v104
  v_exp_f32 v105, v105
  v_exp_f32 v106, v106
  v_exp_f32 v107, v107
  v_exp_f32 v108, v108
  v_exp_f32 v109, v109
  v_exp_f32 v110, v110
  v_exp_f32 v111, v111
  v_exp_f32 v112, v112
  v_exp_f32 v113, v113
  v_exp_f32 v114, v114
  v_exp_f32 v115, v115
  v_exp_f32 v116, v116
  v_exp_f32 v117, v117
  v_exp_f32 v118, v118
  v_exp_f32 v119, v119
  v_exp_f32 v120, v120
  v_exp_f32 v121, v121
  v_exp_f32 v122, v122
  v_exp_f32 v123, v123
  v_exp_f32 v124, v124
  v_exp_f32 v125, v125
  v_exp_f32 v126, v126
  v_exp_f32 v127, v127
  v_pk_add_f32 v[96:97], v[130:131], v[96:97]
  v_pk_add_f32 v[98:99], v[130:131], v[98:99]
  v_pk_add_f32 v[100:101], v[130:131], v[100:101]
  v_pk_add_f32 v[102:103], v[130:131], v[102:103]
  v_pk_add_f32 v[104:105], v[130:131], v[104:105]
  v_pk_add_f32 v[106:107], v[130:131], v[106:107]
  v_pk_add_f32 v[108:109], v[130:131], v[108:109]
  v_pk_add_f32 v[110:111], v[130:131], v[110:111]
  v_pk_add_f32 v[112:113], v[130:131], v[112:113]
  v_pk_add_f32 v[114:115], v[130:131], v[114:115]
  v_pk_add_f32 v[116:117], v[130:131], v[116:117]
  v_pk_add_f32 v[118:119], v[130:131], v[118:119]
  v_pk_add_f32 v[120:121], v[130:131], v[120:121]
  v_pk_add_f32 v[122:123], v[130:131], v[122:123]
  v_pk_add_f32 v[124:125], v[130:131], v[124:125]
  v_pk_add_f32 v[126:127], v[130:131], v[126:127]
  v_rcp_f32 v96, v96
  v_rcp_f32 v97, v97
  v_rcp_f32 v98, v98
  v_rcp_f32 v99, v99
  v_rcp_f32 v100, v100
  v_rcp_f32 v101, v101
  v_rcp_f32 v102, v102
  v_rcp_f32 v103, v103
  v_rcp_f32 v104, v104
  v_rcp_f32 v105, v105
  v_rcp_f32 v106, v106
  v_rcp_f32 v107, v107
  v_rcp_f32 v108, v108
  v_rcp_f32 v109, v109
  v_rcp_f32 v110, v110
  v_rcp_f32 v111, v111
  v_rcp_f32 v112, v112
  v_rcp_f32 v113, v113
  v_rcp_f32 v114, v114
  v_rcp_f32 v115, v115
  v_rcp_f32 v116, v116
  v_rcp_f32 v117, v117
  v_rcp_f32 v118, v118
  v_rcp_f32 v119, v119
  v_rcp_f32 v120, v120
  v_rcp_f32 v121, v121
  v_rcp_f32 v122, v122
  v_rcp_f32 v123, v123
  v_rcp_f32 v124, v124
  v_rcp_f32 v125, v125
  v_rcp_f32 v126, v126
  v_rcp_f32 v127, v127
  v_pk_mul_f32 v[224:225], v[224:225], v[96:97]
  v_pk_mul_f32 v[226:227], v[226:227], v[98:99]
  v_pk_mul_f32 v[228:229], v[228:229], v[100:101]
  v_pk_mul_f32 v[230:231], v[230:231], v[102:103]
  v_pk_mul_f32 v[232:233], v[232:233], v[104:105]
  v_pk_mul_f32 v[234:235], v[234:235], v[106:107]
  v_pk_mul_f32 v[236:237], v[236:237], v[108:109]
  v_pk_mul_f32 v[238:239], v[238:239], v[110:111]
  v_pk_mul_f32 v[240:241], v[240:241], v[112:113]
  v_pk_mul_f32 v[242:243], v[242:243], v[114:115]
  v_pk_mul_f32 v[244:245], v[244:245], v[116:117]
  v_pk_mul_f32 v[246:247], v[246:247], v[118:119]
  v_pk_mul_f32 v[248:249], v[248:249], v[120:121]
  v_pk_mul_f32 v[250:251], v[250:251], v[122:123]
  v_pk_mul_f32 v[252:253], v[252:253], v[124:125]
  v_pk_mul_f32 v[254:255], v[254:255], v[126:127]
  v_permlane16_swap_b32 v224, v228
  v_permlane16_swap_b32 v225, v229
  v_permlane16_swap_b32 v226, v230
  v_permlane16_swap_b32 v227, v231
  v_permlane16_swap_b32 v232, v236
  v_permlane16_swap_b32 v233, v237
  v_permlane16_swap_b32 v234, v238
  v_permlane16_swap_b32 v235, v239
  v_permlane16_swap_b32 v240, v244
  v_permlane16_swap_b32 v241, v245
  v_permlane16_swap_b32 v242, v246
  v_permlane16_swap_b32 v243, v247
  v_permlane16_swap_b32 v248, v252
  v_permlane16_swap_b32 v249, v253
  v_permlane16_swap_b32 v250, v254
  v_permlane16_swap_b32 v251, v255
  v_and_b32 v104, 0x3fff, v12
  v_bfe_u32 v105, v2, 3, 1
  v_lshl_add_u32 v104, v105, 6, v104
  s_waitcnt vmcnt(0)
  v_lshlrev_b32 v96, 16, v192
  v_and_b32 v97, 0xffff0000, v192
  v_lshlrev_b32 v98, 16, v208
  v_and_b32 v99, 0xffff0000, v208
  v_pk_fma_f32 v[96:97], v[98:99], v[224:225], v[96:97]
  v_cvt_pk_bf16_f32 v192, v96, v97
  v_lshlrev_b32 v96, 16, v193
  v_and_b32 v97, 0xffff0000, v193
  v_lshlrev_b32 v98, 16, v209
  v_and_b32 v99, 0xffff0000, v209
  v_pk_fma_f32 v[96:97], v[98:99], v[226:227], v[96:97]
  v_cvt_pk_bf16_f32 v193, v96, v97
  v_lshlrev_b32 v96, 16, v194
  v_and_b32 v97, 0xffff0000, v194
  v_lshlrev_b32 v98, 16, v210
  v_and_b32 v99, 0xffff0000, v210
  v_pk_fma_f32 v[96:97], v[98:99], v[228:229], v[96:97]
  v_cvt_pk_bf16_f32 v194, v96, v97
  v_lshlrev_b32 v96, 16, v195
  v_and_b32 v97, 0xffff0000, v195
  v_lshlrev_b32 v98, 16, v211
  v_and_b32 v99, 0xffff0000, v211
  v_pk_fma_f32 v[96:97], v[98:99], v[230:231], v[96:97]
  v_cvt_pk_bf16_f32 v195, v96, v97
  v_lshlrev_b32 v96, 16, v196
  v_and_b32 v97, 0xffff0000, v196
  v_lshlrev_b32 v98, 16, v212
  v_and_b32 v99, 0xffff0000, v212
  v_pk_fma_f32 v[96:97], v[98:99], v[232:233], v[96:97]
  v_cvt_pk_bf16_f32 v196, v96, v97
  v_lshlrev_b32 v96, 16, v197
  v_and_b32 v97, 0xffff0000, v197
  v_lshlrev_b32 v98, 16, v213
  v_and_b32 v99, 0xffff0000, v213
  v_pk_fma_f32 v[96:97], v[98:99], v[234:235], v[96:97]
  v_cvt_pk_bf16_f32 v197, v96, v97
  v_lshlrev_b32 v96, 16, v198
  v_and_b32 v97, 0xffff0000, v198
  v_lshlrev_b32 v98, 16, v214
  v_and_b32 v99, 0xffff0000, v214
  v_pk_fma_f32 v[96:97], v[98:99], v[236:237], v[96:97]
  v_cvt_pk_bf16_f32 v198, v96, v97
  v_lshlrev_b32 v96, 16, v199
  v_and_b32 v97, 0xffff0000, v199
  v_lshlrev_b32 v98, 16, v215
  v_and_b32 v99, 0xffff0000, v215
  v_pk_fma_f32 v[96:97], v[98:99], v[238:239], v[96:97]
  v_cvt_pk_bf16_f32 v199, v96, v97
  v_mov_b32 v100, v192
  v_mov_b32 v101, v193
  v_mov_b32 v102, v194
  v_mov_b32 v103, v195
  s_nop 1
  v_mov_b32_dpp v192, v196 row_ror:8 row_mask:0xf bank_mask:0xc
  v_mov_b32_dpp v193, v197 row_ror:8 row_mask:0xf bank_mask:0xc
  v_mov_b32_dpp v194, v198 row_ror:8 row_mask:0xf bank_mask:0xc
  v_mov_b32_dpp v195, v199 row_ror:8 row_mask:0xf bank_mask:0xc
  v_mov_b32_dpp v196, v100 row_ror:8 row_mask:0xf bank_mask:0x3
  v_mov_b32_dpp v197, v101 row_ror:8 row_mask:0xf bank_mask:0x3
  v_mov_b32_dpp v198, v102 row_ror:8 row_mask:0xf bank_mask:0x3
  v_mov_b32_dpp v199, v103 row_ror:8 row_mask:0xf bank_mask:0x3
  buffer_store_dwordx4 v[192:195], v104, s[40:43], s30 offen sc0 sc1
  s_add_u32 s30, s30, 0x4000
  buffer_store_dwordx4 v[196:199], v104, s[40:43], s30 offen sc0 sc1
  s_add_u32 s30, s30, 0x4000
  v_lshlrev_b32 v96, 16, v200
  v_and_b32 v97, 0xffff0000, v200
  v_lshlrev_b32 v98, 16, v216
  v_and_b32 v99, 0xffff0000, v216
  v_pk_fma_f32 v[96:97], v[98:99], v[240:241], v[96:97]
  v_cvt_pk_bf16_f32 v200, v96, v97
  v_lshlrev_b32 v96, 16, v201
  v_and_b32 v97, 0xffff0000, v201
  v_lshlrev_b32 v98, 16, v217
  v_and_b32 v99, 0xffff0000, v217
  v_pk_fma_f32 v[96:97], v[98:99], v[242:243], v[96:97]
  v_cvt_pk_bf16_f32 v201, v96, v97
  v_lshlrev_b32 v96, 16, v202
  v_and_b32 v97, 0xffff0000, v202
  v_lshlrev_b32 v98, 16, v218
  v_and_b32 v99, 0xffff0000, v218
  v_pk_fma_f32 v[96:97], v[98:99], v[244:245], v[96:97]
  v_cvt_pk_bf16_f32 v202, v96, v97
  v_lshlrev_b32 v96, 16, v203
  v_and_b32 v97, 0xffff0000, v203
  v_lshlrev_b32 v98, 16, v219
  v_and_b32 v99, 0xffff0000, v219
  v_pk_fma_f32 v[96:97], v[98:99], v[246:247], v[96:97]
  v_cvt_pk_bf16_f32 v203, v96, v97
  v_lshlrev_b32 v96, 16, v204
  v_and_b32 v97, 0xffff0000, v204
  v_lshlrev_b32 v98, 16, v220
  v_and_b32 v99, 0xffff0000, v220
  v_pk_fma_f32 v[96:97], v[98:99], v[248:249], v[96:97]
  v_cvt_pk_bf16_f32 v204, v96, v97
  v_lshlrev_b32 v96, 16, v205
  v_and_b32 v97, 0xffff0000, v205
  v_lshlrev_b32 v98, 16, v221
  v_and_b32 v99, 0xffff0000, v221
  v_pk_fma_f32 v[96:97], v[98:99], v[250:251], v[96:97]
  v_cvt_pk_bf16_f32 v205, v96, v97
  v_lshlrev_b32 v96, 16, v206
  v_and_b32 v97, 0xffff0000, v206
  v_lshlrev_b32 v98, 16, v222
  v_and_b32 v99, 0xffff0000, v222
  v_pk_fma_f32 v[96:97], v[98:99], v[252:253], v[96:97]
  v_cvt_pk_bf16_f32 v206, v96, v97
  v_lshlrev_b32 v96, 16, v207
  v_and_b32 v97, 0xffff0000, v207
  v_lshlrev_b32 v98, 16, v223
  v_and_b32 v99, 0xffff0000, v223
  v_pk_fma_f32 v[96:97], v[98:99], v[254:255], v[96:97]
  v_cvt_pk_bf16_f32 v207, v96, v97
  v_mov_b32 v100, v200
  v_mov_b32 v101, v201
  v_mov_b32 v102, v202
  v_mov_b32 v103, v203
  s_nop 1
  v_mov_b32_dpp v200, v204 row_ror:8 row_mask:0xf bank_mask:0xc
  v_mov_b32_dpp v201, v205 row_ror:8 row_mask:0xf bank_mask:0xc
  v_mov_b32_dpp v202, v206 row_ror:8 row_mask:0xf bank_mask:0xc
  v_mov_b32_dpp v203, v207 row_ror:8 row_mask:0xf bank_mask:0xc
  v_mov_b32_dpp v204, v100 row_ror:8 row_mask:0xf bank_mask:0x3
  v_mov_b32_dpp v205, v101 row_ror:8 row_mask:0xf bank_mask:0x3
  v_mov_b32_dpp v206, v102 row_ror:8 row_mask:0xf bank_mask:0x3
  v_mov_b32_dpp v207, v103 row_ror:8 row_mask:0xf bank_mask:0x3
  buffer_store_dwordx4 v[200:203], v104, s[40:43], s30 offen sc0 sc1
  s_add_u32 s30, s30, 0x4000
  buffer_store_dwordx4 v[204:207], v104, s[40:43], s30 offen sc0 sc1
  s_add_u32 s30, s30, 0x4000
k1_end:
  s_endpgm
.section .rodata,"a"
.p2align 6
.amdhsa_kernel recurrent_scan__spectral_gfnet__glu_gated_bilinear__prompt_kernel
  .amdhsa_next_free_vgpr 256
  .amdhsa_next_free_sgpr 96
  .amdhsa_accum_offset 256
  .amdhsa_group_segment_fixed_size 0
  .amdhsa_kernarg_size 80
  .amdhsa_user_sgpr_count 2
  .amdhsa_user_sgpr_kernarg_segment_ptr 1
  .amdhsa_system_sgpr_workgroup_id_x 1
.end_amdhsa_kernel
```
